```python
import torch

def _softmax(x, axis=-1):
    return torch.softmax(x, dim=axis)
def _gelu(x):
    return torch.nn.functional.gelu(x, approximate="tanh")
def _silu(x):
    return torch.nn.functional.silu(x)
def _sigmoid(x):
    return torch.sigmoid(x)
def _layernorm(x, axis=-1, eps=1e-5):
    m = x.mean(dim=axis, keepdim=True)
    v = x.var(dim=axis, keepdim=True, unbiased=False)
    return (x - m) / torch.sqrt(v + eps)
def _scatter_add(tgt, idx, src, axis=0):
    return tgt.clone().index_add_(axis, idx, src)
def _segment_sum(src, seg, n):
    out = torch.zeros((n,) + src.shape[1:], dtype=src.dtype)
    return out.index_add_(0, seg, src)
def _pad(x, pw):
    flat = tuple(v for pair in reversed(pw) for v in pair)
    return torch.nn.functional.pad(x, flat)

kernel_name = 'sequential_preLN__sliding_block__mixer_channel_mlp__prompt'

def setup_inputs():

    _w = (lambda a: (lambda t: t.to(torch.bfloat16) if t.is_floating_point() else t)(torch.as_tensor(a)))
    def _A_setup():
        B, S, D = 1, 2048, 512
        return {
            "x": _w((lambda *s: torch.randn(*s, dtype=torch.bfloat16) * 0.05)(B, S, D)),
            "wqkv": _w((lambda *s: torch.randn(*s, dtype=torch.bfloat16) * 0.05)(D, 3 * D)),
            "wo": _w((lambda *s: torch.randn(*s, dtype=torch.bfloat16) * 0.05)(D, D)),
        }
    _A_in = _A_setup()

    def _B_setup():
        B, S, D, F = 1, 2048, 512, 1376
        return {
            "x": _w((lambda *s: torch.randn(*s, dtype=torch.bfloat16) * 0.05)(B, S, D)),
            "w1": _w((lambda *s: torch.randn(*s, dtype=torch.bfloat16) * 3.2)(D, F) * (D ** -0.5)),
            "b1": _w((lambda *s: torch.randn(*s, dtype=torch.bfloat16) * 1.6)(F)),
            "w2": _w((lambda *s: torch.randn(*s, dtype=torch.bfloat16) * 0.2)(F, D) * (F ** -0.5)),
            "b2": _w((lambda *s: torch.randn(*s, dtype=torch.bfloat16) * 0.2)(D)),
        }
    _B_in = _B_setup()

    return {
        "A_x": _A_in["x"],
        "A_wqkv": _A_in["wqkv"],
        "A_wo": _A_in["wo"],
        "B_x": _B_in["x"],
        "B_w1": _B_in["w1"],
        "B_b1": _B_in["b1"],
        "B_w2": _B_in["w2"],
        "B_b2": _B_in["b2"],
    }

def reference(A_x, A_wqkv, A_wo, B_x, B_w1, B_b1, B_w2, B_b2):
    def _A_ref(x, wqkv, wo):
        B, S, D = x.shape
        H = 32; Dh = D // H; W = 256
        qkv = (lambda x, *d: x.permute(*d))((x @ wqkv).reshape(B, S, 3, H, Dh), 2, 0, 3, 1, 4)
        q, k, v = qkv[0], qkv[1], qkv[2]
        scores = torch.einsum("bhqd,bhkd->bhqk", q, k) * (Dh ** -0.5)
        idx = torch.arange(S)
        mask = (idx[:, None] - idx[None, :] >= 0) & (idx[:, None] - idx[None, :] < W)
        scores = torch.where(mask[None, None], scores, -1e9)
        p = _softmax(scores, axis=-1)
        o = torch.einsum("bhqk,bhkd->bhqd", p, v)
        return (lambda x, *d: x.permute(*d))(o, 0, 2, 1, 3).reshape(B, S, D) @ wo

    def _B_ref(x, w1, b1, w2, b2):
        y = _layernorm(x, axis=-1)
        h = _gelu(torch.einsum("bsd,df->bsf", y, w1) + b1)
        return torch.einsum("bsf,fd->bsd", h, w2) + b2

    x = A_x
    h = x + _A_ref(_layernorm(x, axis=-1), A_wqkv, A_wo)
    h2 = h + _B_ref(_layernorm(h, axis=-1), B_w1, B_b1, B_w2, B_b2)
    return h2
```

```asm
; @launch grid=(256,1,1) block=(256,1,1) lds=163840
.amdgcn_target "amdgcn-amd-amdhsa--gfx950"
.text
.globl sequential_preLN__sliding_block__mixer_channel_mlp__prompt_kernel
.p2align 8
.type sequential_preLN__sliding_block__mixer_channel_mlp__prompt_kernel,@function
sequential_preLN__sliding_block__mixer_channel_mlp__prompt_kernel:
    s_load_dwordx2 s[8:9], s[0:1], 0
    s_load_dwordx2 s[32:33], s[0:1], 80
    s_cmpk_ge_u32 s2, 256
    s_cbranch_scc1 L_end
    s_getpc_b64 s[48:49]
L_pc0:
    s_mov_b32 s50, L_cold-L_pc0
    s_mov_b32 s51, 0x20000
    s_lshr_b32 s62, s2, 3
    v_lshl_add_u32 v3, s62, 8, v0
    v_lshlrev_b32 v3, 2, v3
    buffer_load_dword v3, v3, s[48:51], 0 offen
    s_load_dwordx2 s[12:13], s[0:1], 8
    v_lshrrev_b32 v1, 6, v0
    s_and_b32 s65, s2, 7
    v_readfirstlane_b32 s52, v1
    v_and_b32 v1, 63, v0
    s_and_b32 s53, s62, 7
    s_lshr_b32 s64, s62, 3
    s_lshl2_add_u32 s54, s65, s64
    s_mov_b32 s11, 0x20000
    v_lshrrev_b32 v8, 3, v1
    v_and_b32 v9, 7, v1
    s_lshl_b32 s64, s52, 14
    v_lshl_add_u32 v6, v8, 10, s64
    v_lshl_add_u32 v6, v9, 4, v6
    v_add_u32 v11, 8192, v6
    s_lshl2_add_u32 s3, s62, s52
    s_lshl_b32 s62, s54, 16
    s_lshl_b32 s63, s53, 7
    s_mov_b32 s66, s63
    s_sub_u32 s10, 2097152, s62
    s_waitcnt lgkmcnt(0)
    s_add_u32 s8, s8, s62
    s_addc_u32 s9, s9, 0
    buffer_load_dwordx4 v[64:67], v6, s[8:11], s66 offen nt
    buffer_load_dwordx4 v[68:71], v11, s[8:11], s66 offen nt
    s_add_u32 s66, s66, 128
    s_and_b32 s66, s66, 0x380
    buffer_load_dwordx4 v[72:75], v6, s[8:11], s66 offen nt
    buffer_load_dwordx4 v[76:79], v11, s[8:11], s66 offen nt
    s_load_dwordx2 s[16:17], s[0:1], 16
    s_load_dwordx2 s[20:21], s[0:1], 32
    s_load_dwordx2 s[40:41], s[0:1], 40
    s_load_dwordx2 s[24:25], s[0:1], 48
    s_load_dwordx2 s[44:45], s[0:1], 56
    s_load_dwordx2 s[28:29], s[0:1], 64
    s_load_dwordx2 s[36:37], s[0:1], 72
    s_mov_b32 s14, 1572864
    s_mov_b32 s15, 0x20000
    s_lshr_b32 s58, s52, 1
    s_and_b32 s59, s52, 1
    s_lshl_b32 s77, s52, 12
    s_lshl3_add_u32 s55, s54, s53
    s_and_b32 s57, s55, 15
    s_lshl1_add_u32 s64, s2, s58
    s_mul_i32 s64, s64, 24
    s_lshl3_add_u32 s65, s59, s64
    v_add_lshl_u32 v198, v1, s65, 7
    s_lshl2_add_u32 s65, s59, s64
    v_add_lshl_u32 v199, v1, s65, 7
    s_mov_b64 exec, 255
    buffer_load_dword v198, v198, s[12:15], 0 offen offset:1024
    s_mov_b64 exec, -1
    s_mov_b32 s34, 17825792
    s_mov_b32 s35, 0x20000
    s_mov_b32 s18, 524288
    s_mov_b32 s19, 0x20000
    s_mov_b32 s22, 1409024
    s_mov_b32 s23, 0x20000
    s_mov_b32 s26, 1409024
    s_mov_b32 s27, 0x20000
    s_mov_b32 s38, 256
    s_mov_b32 s39, 0x20000
    s_mov_b32 s42, 2752
    s_mov_b32 s43, 0x20000
    s_add_u32 s66, s66, 128
    s_and_b32 s66, s66, 0x380
    buffer_load_dwordx4 v[80:83], v6, s[8:11], s66 offen nt
    s_mov_b32 s46, 1024
    s_mov_b32 s47, 0x20000
    v_lshlrev_b32 v2, 4, v1
    v_and_b32 v20, 31, v1
    v_lshrrev_b32 v21, 5, v1
    v_mov_b32 v5, 0
    v_mov_b32 v176, 0
    v_mov_b32 v177, 0
    v_mov_b32 v178, 0
    v_mov_b32 v179, 0
    s_lshl_b32 s68, s55, 7
    s_lshr_b32 s56, s55, 4
    buffer_load_dwordx4 v[84:87], v11, s[8:11], s66 offen nt
    s_lshl_b32 s56, s56, 10
    s_add_u32 s56, s56, 32768
    v_lshl_add_u32 v40, v1, 7, s68
    s_sub_u32 s64, s56, 256
    v_add_u32 v41, s64, v2
    v_cmp_gt_u32 vcc, 16, v1
    s_or_b32 s64, s57, s52
    s_mov_b32 s101, 0
    v_cndmask_b32 v40, v41, v40, vcc
    s_cmp_eq_u32 s64, 0
    s_cselect_b32 s100, 1, 0
    s_cselect_b64 exec, -1, 0
    buffer_store_dwordx4 v[176:179], v40, s[32:35], 0 offen sc1
    s_mov_b64 exec, -1
    s_add_u32 s66, s66, 128
    s_and_b32 s66, s66, 0x380
    buffer_load_dwordx4 v[88:91], v6, s[8:11], s66 offen nt
    v_lshrrev_b32 v10, 2, v1
    v_and_b32 v10, 4, v10
    v_xor_b32_e64 v10, v10, v9
    v_lshl_add_u32 v10, v10, 4, s63
    v_lshl_add_u32 v12, v8, 10, v10
    v_add_u32 v13, 7168, v12
    v_add_u32 v14, 14336, v12
    v_add_u32 v15, 21504, v12
    v_lshl_add_u32 v10, v8, 11, v12
    s_mul_i32 s64, s52, 49152
    v_add_u32 v182, s64, v10
    v_add_u32 v180, 1024, v182
    v_add_u32 v181, 24576, v182
    v_add_u32 v183, 23552, v182
    s_mul_i32 s64, s59, 98304
    v_add_u32 v184, s64, v10
    v_add_u32 v185, 23552, v184
    v_add_u32 v186, 47104, v184
    v_add_u32 v187, 70656, v184
    s_mov_b32 s60, 0x3f803f80
    s_mov_b32 s61, 0xffff0000
    s_mov_b32 s96, 0xffff
    s_mov_b32 s97, 0xffff
    s_min_u32 s81, s52, 2
    s_mul_i32 s95, s52, 3072
    s_mul_i32 s84, s53, 196608
    s_add_u32 s64, s53, 1
    s_and_b32 s64, s64, 7
    s_mul_i32 s85, s64, 196608
    s_add_u32 s64, s53, 2
    s_and_b32 s64, s64, 7
    s_mul_i32 s86, s64, 196608
    s_add_u32 s64, s53, 3
    s_and_b32 s64, s64, 7
    s_mul_i32 s87, s64, 196608
    s_add_u32 s64, s53, 4
    s_and_b32 s64, s64, 7
    s_mul_i32 s88, s64, 196608
    s_add_u32 s64, s53, 5
    s_and_b32 s64, s64, 7
    s_mul_i32 s89, s64, 196608
    s_add_u32 s64, s53, 6
    s_and_b32 s64, s64, 7
    s_mul_i32 s90, s64, 196608
    s_add_u32 s64, s53, 7
    s_and_b32 s64, s64, 7
    s_mul_i32 s91, s64, 196608
    s_add_u32 s62, s62, s63
    s_waitcnt lgkmcnt(0)
    s_add_u32 s28, s28, s62
    s_addc_u32 s29, s29, 0
    s_sub_u32 s30, 2097152, s62
    s_mov_b32 s31, 0x20000
    s_mov_b64 s[48:49], s[32:33]
    s_cmp_eq_u32 s52, 0
    s_cselect_b64 s[98:99], 1, 0
    s_getreg_b32 s64, hwreg(HW_REG_XCC_ID, 0, 4)
    s_lshl1_add_u32 s64, s64, 1
    v_mov_b32_e64 v4, s64
    v_accvgpr_write_b32 a224, s60
    v_accvgpr_write_b32 a225, s60
    v_accvgpr_write_b32 a226, s60
    v_accvgpr_write_b32 a227, s60
    v_accvgpr_write_b32 a228, s60
    v_accvgpr_write_b32 a229, s60
    v_accvgpr_write_b32 a230, s60
    v_accvgpr_write_b32 a231, s60
    v_accvgpr_write_b32 a232, s60
    v_accvgpr_write_b32 a233, s60
    v_accvgpr_write_b32 a234, s60
    v_accvgpr_write_b32 a235, s60
    v_accvgpr_write_b32 a236, s60
    v_accvgpr_write_b32 a237, s60
    v_accvgpr_write_b32 a238, s60
    v_accvgpr_write_b32 a239, s60
    s_cmp_ge_u32 s54, 4
    s_cselect_b32 s73, 17825792, 0
    v_mfma_f32_32x32x16_bf16 a[160:175], v[176:179], v[176:179], a[224:239]
    v_lshlrev_b32 v42, 2, v21
    v_sub_u32 v42, v20, v42
    v_cvt_f32_i32 v42, v42
    v_mov_b32 v43, 0x7149f2ca
    v_fmaak_f32 v224, v42, v43, 0x70c9f2ca
    v_fmaak_f32 v225, v42, v43, 0xf0c9f2ca
    v_fmaak_f32 v226, v42, v43, 0xf1977617
    v_fmaak_f32 v227, v42, v43, 0xf1fc6f7c
    v_fmaak_f32 v228, v42, v43, 0xf2bd539d
    v_fmaak_f32 v229, v42, v43, 0xf2d691f6
    v_fmaak_f32 v230, v42, v43, 0xf2efd050
    v_fmaak_f32 v231, v42, v43, 0xf3048754
    v_fmaak_f32 v232, v42, v43, 0xf343a333
    s_cmp_ge_u32 s54, 3
    s_cselect_b32 s74, 17825792, 0
    v_mfma_f32_32x32x16_bf16 a[176:191], v[176:179], v[176:179], a[224:239]
    v_fmaak_f32 v233, v42, v43, 0xf3504260
    v_fmaak_f32 v234, v42, v43, 0xf35ce18d
    v_fmaak_f32 v235, v42, v43, 0xf36980b9
    v_fmaak_f32 v236, v42, v43, 0xf3944e4c
    v_fmaak_f32 v237, v42, v43, 0xf39a9de3
    v_fmaak_f32 v238, v42, v43, 0xf3a0ed79
    v_fmaak_f32 v239, v42, v43, 0xf3a73d0f
    v_min_f32 v208, 0, v224
    v_min_f32_e64 v224, 0, -v224
    v_min_f32 v209, 0, v225
    v_min_f32_e64 v225, 0, -v225
    v_min_f32 v210, 0, v226
    v_min_f32_e64 v226, 0, -v226
    s_cmp_ge_u32 s54, 2
    s_cselect_b32 s75, 17825792, 0
    v_mfma_f32_32x32x16_bf16 a[192:207], v[176:179], v[176:179], a[224:239]
    v_min_f32 v211, 0, v227
    v_min_f32_e64 v227, 0, -v227
    v_min_f32 v212, 0, v228
    v_min_f32_e64 v228, 0, -v228
    v_min_f32 v213, 0, v229
    v_min_f32_e64 v229, 0, -v229
    v_min_f32 v214, 0, v230
    v_min_f32_e64 v230, 0, -v230
    v_min_f32 v215, 0, v231
    v_min_f32_e64 v231, 0, -v231
    v_min_f32 v216, 0, v232
    v_min_f32_e64 v232, 0, -v232
    v_min_f32 v217, 0, v233
    s_cmp_ge_u32 s54, 1
    s_cselect_b32 s76, 17825792, 0
    v_mfma_f32_32x32x16_bf16 a[208:223], v[176:179], v[176:179], a[224:239]
    v_min_f32_e64 v233, 0, -v233
    v_min_f32 v218, 0, v234
    v_min_f32_e64 v234, 0, -v234
    v_min_f32 v219, 0, v235
    v_min_f32_e64 v235, 0, -v235
    v_min_f32 v220, 0, v236
    v_min_f32_e64 v236, 0, -v236
    v_min_f32 v221, 0, v237
    v_min_f32_e64 v237, 0, -v237
    v_min_f32 v222, 0, v238
    v_min_f32_e64 v238, 0, -v238
    v_min_f32 v223, 0, v239
    v_min_f32_e64 v239, 0, -v239
    s_cmp_lt_u32 s54, 4
    s_cbranch_scc1 L_head
L_head_r:
    v_xor_b32 v41, v8, v9
    v_lshlrev_b32 v41, 4, v41
    v_lshl_add_u32 v188, v9, 9, v41
    s_lshl_b32 s64, s58, 12
    s_lshl_b32 s65, s59, 8
    s_add_u32 s65, s65, s64
    v_add_u32 v188, s65, v188
    v_xor_b32 v189, v21, v1
    v_lshl_add_u32 v189, v189, 4, s64
    v_xor_b32 v190, 32, v189
    v_xor_b32 v191, 64, v189
    v_xor_b32 v192, 96, v189
    v_bfe_u32 v42, v20, 1, 3
    s_lshl_b32 s65, s59, 2
    v_xor_b32 v42, s65, v42
    v_lshl_add_u32 v42, v42, 4, s64
    v_lshl_add_u32 v42, v20, 7, v42
    v_lshl_add_u32 v248, v21, 3, v42
    v_xor_b32 v249, 16, v248
    v_xor_b32 v250, 32, v248
    v_xor_b32 v251, 48, v248
    v_bfe_u32 v42, v1, 2, 2
    v_lshrrev_b32 v43, 1, v42
    v_xor_b32 v43, s59, v43
    v_bfe_u32 v41, v1, 4, 1
    v_and_b32 v44, 3, v1
    v_lshlrev_b32 v45, 3, v44
    v_lshl_add_u32 v45, v41, 5, v45
    v_lshl_add_u32 v43, v43, 6, v45
    v_lshl_add_u32 v30, v42, 7, v43
    v_lshl_add_u32 v42, v21, 2, v42
    v_mul_u32_u24 v31, 192, v42
    v_add_u32 v31, v31, v45
    v_add_u32 v34, 0x10000, v31
    v_lshl_add_u32 v193, v21, 10, v30
    v_add_u32 v194, 0x10000, v193
    v_add_u32 v195, 0x20000, v193
    v_lshl_add_u32 v30, v21, 9, v30
    s_lshl_b32 s64, s59, 14
    s_add_u32 s64, s64, 98304
    v_add_u32 v32, s64, v30
    v_xor_b32 v33, 64, v32
    s_lshr_b32 s64, s55, 4
    v_min_u32 v196, 2, v44
    v_sub_u32 v196, s64, v196
    v_max_i32 v196, 0, v196
    v_lshlrev_b32 v196, 2, v196
    s_sub_u32 s65, s55, 32
    v_lshl_add_u32 v197, v44, 3, s65
    v_mov_b32 v44, s55
    v_cmp_gt_i32 vcc, 0, v197
    v_and_b32 v29, 15, v1
    v_lshlrev_b32 v35, 4, v29
    v_cndmask_b32 v197, v197, v44, vcc
    v_lshlrev_b32 v197, 7, v197
    s_and_b32 s64, s55, 0xf0
    v_add_lshl_u32 v40, v29, s64, 7
    v_lshlrev_b32 v29, 2, v29
    v_lshl_add_u32 v35, v21, 8, v35
    v_lshl_add_u32 v240, v41, 11, v35
    s_lshl_b32 s65, s95, 1
    v_add_u32 v241, s65, v2
    v_mul_u32_u24 v242, 3072, v41
    v_add3_u32 v242, v242, v35, s65
    v_add_u32 v245, s95, v2
    v_add_u32 v246, s95, v35
    v_lshrrev_b32 v42, 1, v8
    v_xor_b32 v42, v42, v9
    s_lshl_b32 s65, s52, 11
    v_lshl_add_u32 v42, v42, 4, s65
    v_lshl_add_u32 v243, v8, 7, v42
    v_xor_b32 v244, 64, v243
    s_lshl1_add_u32 s64, s54, s58
    s_lshl3_add_u32 s64, s64, s53
    s_lshl1_add_u32 s94, s64, s59
    s_lshl_b32 s92, s94, 12
    s_add_u32 s92, s92, 1048576
    s_lshl4_add_u32 s93, s54, s53
    s_lshl2_add_u32 s93, s93, s52
    s_lshl2_add_u32 s69, s57, s52
    s_lshl2_add_u32 s69, s69, s56
    v_mov_b32 v22, 0x5f800000
    s_min_u32 s62, s57, 11
    s_lshl1_add_u32 s62, s57, s62
    s_lshl_b32 s62, s62, 6
    s_mul_i32 s64, s52, 44032
    s_add_u32 s64, s64, s62
    v_add_u32 v41, s64, v2
    s_movk_i32 s64, 2560
    s_cmp_lt_u32 s57, 11
    s_cselect_b32 s7, 0, 0x40000000
    v_add_u32 v42, 0, v1
    v_mul_u32_u24 v43, 0x5556, v42
    v_lshrrev_b32 v43, 18, v43
    v_mad_i32_i24 v42, v43, -12, v42
    v_mad_u32_u24 v23, v43, s64, v41
    v_lshrrev_b32 v42, 3, v42
    v_mul_lo_u32 v42, v42, s7
    v_add_u32 v23, v23, v42
    v_add_u32 v42, 64, v1
    v_mul_u32_u24 v43, 0x5556, v42
    v_lshrrev_b32 v43, 18, v43
    v_mad_i32_i24 v42, v43, -12, v42
    v_mad_u32_u24 v24, v43, s64, v41
    v_lshrrev_b32 v42, 3, v42
    v_mul_lo_u32 v42, v42, s7
    v_add_u32 v24, v24, v42
    v_add_u32 v42, 128, v1
    v_mul_u32_u24 v43, 0x5556, v42
    v_lshrrev_b32 v43, 18, v43
    v_mad_i32_i24 v42, v43, -12, v42
    v_mad_u32_u24 v25, v43, s64, v41
    v_lshrrev_b32 v42, 3, v42
    v_mul_lo_u32 v42, v42, s7
    v_add_u32 v25, v25, v42
    v_add_u32 v28, 45056, v2
    v_add_u32 v10, s7, v2
    buffer_load_dwordx4 v[92:95], v11, s[8:11], s66 offen nt
    s_add_u32 s66, s66, 128
    s_and_b32 s66, s66, 0x380
    buffer_load_dwordx4 v[96:99], v6, s[8:11], s66 offen nt
    buffer_load_dwordx4 v[100:103], v11, s[8:11], s66 offen nt
    s_add_u32 s66, s66, 128
    s_and_b32 s66, s66, 0x380
    buffer_load_dwordx4 v[104:107], v6, s[8:11], s66 offen nt
    buffer_load_dwordx4 v[108:111], v11, s[8:11], s66 offen nt
    s_waitcnt vmcnt(12)
    v_dot2c_f32_bf16 v176, s60, v64
    s_add_u32 s66, s66, 128
    s_and_b32 s66, s66, 0x380
    buffer_load_dwordx4 v[112:115], v6, s[8:11], s66 offen nt
    buffer_load_dwordx4 v[116:119], v11, s[8:11], s66 offen nt
    v_dot2c_f32_bf16 v177, v64, v64
    s_waitcnt vmcnt(13)
    v_dot2c_f32_bf16 v178, s60, v68
    v_dot2c_f32_bf16 v179, v68, v68
    v_dot2c_f32_bf16 v176, s60, v65
    v_dot2c_f32_bf16 v177, v65, v65
    v_dot2c_f32_bf16 v178, s60, v69
    v_dot2c_f32_bf16 v179, v69, v69
    v_dot2c_f32_bf16 v176, s60, v66
    v_dot2c_f32_bf16 v177, v66, v66
    v_dot2c_f32_bf16 v178, s60, v70
    v_dot2c_f32_bf16 v179, v70, v70
    v_dot2c_f32_bf16 v176, s60, v67
    v_dot2c_f32_bf16 v177, v67, v67
    v_dot2c_f32_bf16 v178, s60, v71
    v_dot2c_f32_bf16 v179, v71, v71
    s_waitcnt vmcnt(12)
    v_dot2c_f32_bf16 v176, s60, v72
    s_add_u32 s66, s66, 128
    s_and_b32 s66, s66, 0x380
    buffer_load_dwordx4 v[120:123], v6, s[8:11], s66 offen nt
    buffer_load_dwordx4 v[124:127], v11, s[8:11], s66 offen nt
    v_dot2c_f32_bf16 v177, v72, v72
    s_waitcnt vmcnt(13)
    v_dot2c_f32_bf16 v178, s60, v76
    v_dot2c_f32_bf16 v179, v76, v76
    v_dot2c_f32_bf16 v176, s60, v73
    v_dot2c_f32_bf16 v177, v73, v73
    v_dot2c_f32_bf16 v178, s60, v77
    v_dot2c_f32_bf16 v179, v77, v77
    v_dot2c_f32_bf16 v176, s60, v74
    v_dot2c_f32_bf16 v177, v74, v74
    v_dot2c_f32_bf16 v178, s60, v78
    v_dot2c_f32_bf16 v179, v78, v78
    v_dot2c_f32_bf16 v176, s60, v75
    v_dot2c_f32_bf16 v177, v75, v75
    v_dot2c_f32_bf16 v178, s60, v79
    v_dot2c_f32_bf16 v179, v79, v79
    s_waitcnt vmcnt(11)
    v_dot2c_f32_bf16 v176, s60, v80
    s_mul_i32 s65, s3, 12
    v_add_lshl_u32 v201, v1, s65, 10
    s_mul_i32 s65, s3, 4
    v_add_lshl_u32 v202, v1, s65, 10
    s_mov_b64 exec, 4095
    buffer_load_dword v201, v201, s[12:15], 0 offen offset:384
    s_mov_b64 exec, 15
    buffer_load_dword v202, v202, s[16:19], 0 offen offset:384
    s_mov_b64 exec, -1
    s_add_u32 m0, s77, 32768
    s_nop 0
    buffer_load_dwordx4 v180, s[12:15], s84 offen offset:0 lds
    v_dot2c_f32_bf16 v177, v80, v80
    s_waitcnt vmcnt(13)
    v_dot2c_f32_bf16 v178, s60, v84
    v_dot2c_f32_bf16 v179, v84, v84
    v_dot2c_f32_bf16 v176, s60, v81
    v_dot2c_f32_bf16 v177, v81, v81
    v_dot2c_f32_bf16 v178, s60, v85
    v_dot2c_f32_bf16 v179, v85, v85
    v_dot2c_f32_bf16 v176, s60, v82
    v_dot2c_f32_bf16 v177, v82, v82
    v_dot2c_f32_bf16 v178, s60, v86
    v_dot2c_f32_bf16 v179, v86, v86
    v_dot2c_f32_bf16 v176, s60, v83
    v_dot2c_f32_bf16 v177, v83, v83
    v_dot2c_f32_bf16 v178, s60, v87
    v_dot2c_f32_bf16 v179, v87, v87
    s_waitcnt vmcnt(12)
    v_dot2c_f32_bf16 v176, s60, v88
    buffer_load_dwordx4 v181, s[12:15], s84 offen offset:1024 lds
    buffer_load_dwordx4 v182, s[12:15], s84 offen offset:2048 lds
    v_dot2c_f32_bf16 v177, v88, v88
    s_waitcnt vmcnt(13)
    v_dot2c_f32_bf16 v178, s60, v92
    v_dot2c_f32_bf16 v179, v92, v92
    v_dot2c_f32_bf16 v176, s60, v89
    v_dot2c_f32_bf16 v177, v89, v89
    v_dot2c_f32_bf16 v178, s60, v93
    v_dot2c_f32_bf16 v179, v93, v93
    v_dot2c_f32_bf16 v176, s60, v90
    v_dot2c_f32_bf16 v177, v90, v90
    v_dot2c_f32_bf16 v178, s60, v94
    v_dot2c_f32_bf16 v179, v94, v94
    v_dot2c_f32_bf16 v176, s60, v91
    v_dot2c_f32_bf16 v177, v91, v91
    v_dot2c_f32_bf16 v178, s60, v95
    v_dot2c_f32_bf16 v179, v95, v95
    s_waitcnt vmcnt(12)
    v_dot2c_f32_bf16 v176, s60, v96
    buffer_load_dwordx4 v183, s[12:15], s84 offen offset:3072 lds
    s_add_u32 m0, s77, 49152
    s_nop 0
    buffer_load_dwordx4 v180, s[12:15], s85 offen offset:0 lds
    v_dot2c_f32_bf16 v177, v96, v96
    s_waitcnt vmcnt(13)
    v_dot2c_f32_bf16 v178, s60, v100
    v_dot2c_f32_bf16 v179, v100, v100
    v_dot2c_f32_bf16 v176, s60, v97
    v_dot2c_f32_bf16 v177, v97, v97
    v_dot2c_f32_bf16 v178, s60, v101
    v_dot2c_f32_bf16 v179, v101, v101
    v_dot2c_f32_bf16 v176, s60, v98
    v_dot2c_f32_bf16 v177, v98, v98
    v_dot2c_f32_bf16 v178, s60, v102
    v_dot2c_f32_bf16 v179, v102, v102
    v_dot2c_f32_bf16 v176, s60, v99
    v_dot2c_f32_bf16 v177, v99, v99
    v_dot2c_f32_bf16 v178, s60, v103
    v_dot2c_f32_bf16 v179, v103, v103
    s_waitcnt vmcnt(12)
    v_dot2c_f32_bf16 v176, s60, v104
    buffer_load_dwordx4 v181, s[12:15], s85 offen offset:1024 lds
    v_dot2c_f32_bf16 v177, v104, v104
    s_waitcnt vmcnt(12)
    v_dot2c_f32_bf16 v178, s60, v108
    v_dot2c_f32_bf16 v179, v108, v108
    v_dot2c_f32_bf16 v176, s60, v105
    v_dot2c_f32_bf16 v177, v105, v105
    v_dot2c_f32_bf16 v178, s60, v109
    v_dot2c_f32_bf16 v179, v109, v109
    v_dot2c_f32_bf16 v176, s60, v106
    v_dot2c_f32_bf16 v177, v106, v106
    v_dot2c_f32_bf16 v178, s60, v110
    v_dot2c_f32_bf16 v179, v110, v110
    v_dot2c_f32_bf16 v176, s60, v107
    v_dot2c_f32_bf16 v177, v107, v107
    v_dot2c_f32_bf16 v178, s60, v111
    v_dot2c_f32_bf16 v179, v111, v111
    s_waitcnt vmcnt(11)
    v_dot2c_f32_bf16 v176, s60, v112
    buffer_load_dwordx4 v182, s[12:15], s85 offen offset:2048 lds
    v_dot2c_f32_bf16 v177, v112, v112
    s_waitcnt vmcnt(11)
    v_dot2c_f32_bf16 v178, s60, v116
    v_dot2c_f32_bf16 v179, v116, v116
    v_dot2c_f32_bf16 v176, s60, v113
    v_dot2c_f32_bf16 v177, v113, v113
    v_dot2c_f32_bf16 v178, s60, v117
    v_dot2c_f32_bf16 v179, v117, v117
    v_dot2c_f32_bf16 v176, s60, v114
    v_dot2c_f32_bf16 v177, v114, v114
    v_dot2c_f32_bf16 v178, s60, v118
    v_dot2c_f32_bf16 v179, v118, v118
    v_dot2c_f32_bf16 v176, s60, v115
    v_dot2c_f32_bf16 v177, v115, v115
    v_dot2c_f32_bf16 v178, s60, v119
    v_dot2c_f32_bf16 v179, v119, v119
    s_waitcnt vmcnt(10)
    v_dot2c_f32_bf16 v176, s60, v120
    buffer_load_dwordx4 v183, s[12:15], s85 offen offset:3072 lds
    v_dot2c_f32_bf16 v177, v120, v120
    s_waitcnt vmcnt(10)
    v_dot2c_f32_bf16 v178, s60, v124
    v_dot2c_f32_bf16 v179, v124, v124
    v_dot2c_f32_bf16 v176, s60, v121
    v_dot2c_f32_bf16 v177, v121, v121
    v_dot2c_f32_bf16 v178, s60, v125
    v_dot2c_f32_bf16 v179, v125, v125
    v_dot2c_f32_bf16 v176, s60, v122
    v_dot2c_f32_bf16 v177, v122, v122
    v_dot2c_f32_bf16 v178, s60, v126
    v_dot2c_f32_bf16 v179, v126, v126
    v_dot2c_f32_bf16 v176, s60, v123
    v_dot2c_f32_bf16 v177, v123, v123
    v_dot2c_f32_bf16 v178, s60, v127
    v_dot2c_f32_bf16 v179, v127, v127
    v_add_f32_dpp v176, v176, v176 quad_perm:[1,0,3,2] row_mask:0xf bank_mask:0xf
    v_add_f32_dpp v177, v177, v177 quad_perm:[1,0,3,2] row_mask:0xf bank_mask:0xf
    v_add_f32_dpp v178, v178, v178 quad_perm:[1,0,3,2] row_mask:0xf bank_mask:0xf
    v_add_f32_dpp v179, v179, v179 quad_perm:[1,0,3,2] row_mask:0xf bank_mask:0xf
    v_add_f32_dpp v176, v176, v176 quad_perm:[2,3,0,1] row_mask:0xf bank_mask:0xf
    v_add_f32_dpp v177, v177, v177 quad_perm:[2,3,0,1] row_mask:0xf bank_mask:0xf
    v_add_f32_dpp v178, v178, v178 quad_perm:[2,3,0,1] row_mask:0xf bank_mask:0xf
    v_add_f32_dpp v179, v179, v179 quad_perm:[2,3,0,1] row_mask:0xf bank_mask:0xf
    v_add_f32_dpp v176, v176, v176 row_half_mirror row_mask:0xf bank_mask:0xf
    v_add_f32_dpp v177, v177, v177 row_half_mirror row_mask:0xf bank_mask:0xf
    v_add_f32_dpp v178, v178, v178 row_half_mirror row_mask:0xf bank_mask:0xf
    v_add_f32_dpp v179, v179, v179 row_half_mirror row_mask:0xf bank_mask:0xf
    v_mul_f32 v176, 0x3b000000, v176
    v_mul_f32 v178, 0x3b000000, v178
    v_mul_f32 v177, 0x3b000000, v177
    v_mul_f32 v179, 0x3b000000, v179
    v_fma_f32 v177, -v176, v176, v177
    v_fma_f32 v179, -v178, v178, v179
    v_max_f32 v177, 0, v177
    v_max_f32 v179, 0, v179
    v_add_f32 v177, 0x3727c5ac, v177
    v_add_f32 v179, 0x3727c5ac, v179
    v_rsq_f32 v177, v177
    v_rsq_f32 v179, v179
    v_mul_f32_e64 v176, -v176, v177
    v_mul_f32_e64 v178, -v178, v179
    v_lshlrev_b32 v160, 16, v64
    v_and_b32 v161, s61, v64
    v_lshlrev_b32 v162, 16, v65
    v_and_b32 v163, s61, v65
    v_lshlrev_b32 v164, 16, v66
    v_and_b32 v165, s61, v66
    v_lshlrev_b32 v166, 16, v67
    v_and_b32 v167, s61, v67
    v_pk_fma_f32 v[160:161], v[160:161], v[176:177], v[176:177] op_sel:[0,1,0] op_sel_hi:[1,1,0]
    v_pk_fma_f32 v[162:163], v[162:163], v[176:177], v[176:177] op_sel:[0,1,0] op_sel_hi:[1,1,0]
    v_pk_fma_f32 v[164:165], v[164:165], v[176:177], v[176:177] op_sel:[0,1,0] op_sel_hi:[1,1,0]
    v_pk_fma_f32 v[166:167], v[166:167], v[176:177], v[176:177] op_sel:[0,1,0] op_sel_hi:[1,1,0]
    v_cvt_pk_bf16_f32 v168, v160, v161
    v_cvt_pk_bf16_f32 v169, v162, v163
    v_cvt_pk_bf16_f32 v170, v164, v165
    v_cvt_pk_bf16_f32 v171, v166, v167
    ds_write_b128 v188, v[168:171] offset:0
    v_lshlrev_b32 v160, 16, v68
    v_and_b32 v161, s61, v68
    v_lshlrev_b32 v162, 16, v69
    v_and_b32 v163, s61, v69
    v_lshlrev_b32 v164, 16, v70
    v_and_b32 v165, s61, v70
    v_lshlrev_b32 v166, 16, v71
    v_and_b32 v167, s61, v71
    v_pk_fma_f32 v[160:161], v[160:161], v[178:179], v[178:179] op_sel:[0,1,0] op_sel_hi:[1,1,0]
    v_pk_fma_f32 v[162:163], v[162:163], v[178:179], v[178:179] op_sel:[0,1,0] op_sel_hi:[1,1,0]
    v_pk_fma_f32 v[164:165], v[164:165], v[178:179], v[178:179] op_sel:[0,1,0] op_sel_hi:[1,1,0]
    v_pk_fma_f32 v[166:167], v[166:167], v[178:179], v[178:179] op_sel:[0,1,0] op_sel_hi:[1,1,0]
    s_add_u32 m0, s77, 65536
    s_nop 0
    buffer_load_dwordx4 v180, s[12:15], s86 offen offset:0 lds
    v_cvt_pk_bf16_f32 v172, v160, v161
    v_cvt_pk_bf16_f32 v173, v162, v163
    v_cvt_pk_bf16_f32 v174, v164, v165
    v_cvt_pk_bf16_f32 v175, v166, v167
    ds_write_b128 v188, v[172:175] offset:128
    v_lshlrev_b32 v160, 16, v72
    v_and_b32 v161, s61, v72
    v_lshlrev_b32 v162, 16, v73
    v_and_b32 v163, s61, v73
    v_lshlrev_b32 v164, 16, v74
    v_and_b32 v165, s61, v74
    v_lshlrev_b32 v166, 16, v75
    v_and_b32_e64 v167, s61, v75
    v_pk_fma_f32 v[160:161], v[160:161], v[176:177], v[176:177] op_sel:[0,1,0] op_sel_hi:[1,1,0]
    v_pk_fma_f32 v[162:163], v[162:163], v[176:177], v[176:177] op_sel:[0,1,0] op_sel_hi:[1,1,0]
    v_pk_fma_f32 v[164:165], v[164:165], v[176:177], v[176:177] op_sel:[0,1,0] op_sel_hi:[1,1,0]
    v_pk_fma_f32 v[166:167], v[166:167], v[176:177], v[176:177] op_sel:[0,1,0] op_sel_hi:[1,1,0]
    buffer_load_dwordx4 v181, s[12:15], s86 offen offset:1024 lds
    v_cvt_pk_bf16_f32 v72, v160, v161
    v_cvt_pk_bf16_f32 v73, v162, v163
    v_cvt_pk_bf16_f32 v74, v164, v165
    v_cvt_pk_bf16_f32 v75, v166, v167
    ds_write_b128 v188, v[72:75] offset:8192
    v_lshlrev_b32 v160, 16, v76
    v_and_b32 v161, s61, v76
    v_lshlrev_b32 v162, 16, v77
    v_and_b32 v163, s61, v77
    v_lshlrev_b32 v164, 16, v78
    v_and_b32 v165, s61, v78
    buffer_load_dwordx4 v182, s[12:15], s86 offen offset:2048 lds
    v_lshlrev_b32 v166, 16, v79
    v_and_b32 v167, s61, v79
    v_pk_fma_f32 v[160:161], v[160:161], v[178:179], v[178:179] op_sel:[0,1,0] op_sel_hi:[1,1,0]
    v_pk_fma_f32 v[162:163], v[162:163], v[178:179], v[178:179] op_sel:[0,1,0] op_sel_hi:[1,1,0]
    v_pk_fma_f32 v[164:165], v[164:165], v[178:179], v[178:179] op_sel:[0,1,0] op_sel_hi:[1,1,0]
    v_pk_fma_f32 v[166:167], v[166:167], v[178:179], v[178:179] op_sel:[0,1,0] op_sel_hi:[1,1,0]
    v_cvt_pk_bf16_f32 v76, v160, v161
    v_cvt_pk_bf16_f32 v77, v162, v163
    v_cvt_pk_bf16_f32 v78, v164, v165
    v_cvt_pk_bf16_f32 v79, v166, v167
    ds_write_b128 v188, v[76:79] offset:8320
    v_lshlrev_b32 v160, 16, v80
    v_and_b32 v161, s61, v80
    v_lshlrev_b32 v162, 16, v81
    v_and_b32 v163, s61, v81
    v_lshlrev_b32 v164, 16, v82
    v_and_b32 v165, s61, v82
    buffer_load_dwordx4 v183, s[12:15], s86 offen offset:3072 lds
    v_lshlrev_b32 v166, 16, v83
    v_and_b32 v167, s61, v83
    v_pk_fma_f32 v[160:161], v[160:161], v[176:177], v[176:177] op_sel:[0,1,0] op_sel_hi:[1,1,0]
    v_pk_fma_f32 v[162:163], v[162:163], v[176:177], v[176:177] op_sel:[0,1,0] op_sel_hi:[1,1,0]
    v_pk_fma_f32 v[164:165], v[164:165], v[176:177], v[176:177] op_sel:[0,1,0] op_sel_hi:[1,1,0]
    v_pk_fma_f32 v[166:167], v[166:167], v[176:177], v[176:177] op_sel:[0,1,0] op_sel_hi:[1,1,0]
    s_add_u32 m0, s77, 81920
    s_nop 0
    buffer_load_dwordx4 v180, s[12:15], s87 offen offset:0 lds
    v_cvt_pk_bf16_f32 v80, v160, v161
    v_cvt_pk_bf16_f32 v81, v162, v163
    v_cvt_pk_bf16_f32 v82, v164, v165
    v_cvt_pk_bf16_f32 v83, v166, v167
    ds_write_b128 v188, v[80:83] offset:16384
    v_lshlrev_b32 v160, 16, v84
    v_and_b32 v161, s61, v84
    v_lshlrev_b32 v162, 16, v85
    v_and_b32 v163, s61, v85
    v_lshlrev_b32 v164, 16, v86
    v_and_b32 v165, s61, v86
    v_lshlrev_b32 v166, 16, v87
    v_and_b32_e64 v167, s61, v87
    v_pk_fma_f32 v[160:161], v[160:161], v[178:179], v[178:179] op_sel:[0,1,0] op_sel_hi:[1,1,0]
    v_pk_fma_f32 v[162:163], v[162:163], v[178:179], v[178:179] op_sel:[0,1,0] op_sel_hi:[1,1,0]
    v_pk_fma_f32 v[164:165], v[164:165], v[178:179], v[178:179] op_sel:[0,1,0] op_sel_hi:[1,1,0]
    v_pk_fma_f32 v[166:167], v[166:167], v[178:179], v[178:179] op_sel:[0,1,0] op_sel_hi:[1,1,0]
    buffer_load_dwordx4 v181, s[12:15], s87 offen offset:1024 lds
    v_cvt_pk_bf16_f32 v84, v160, v161
    v_cvt_pk_bf16_f32 v85, v162, v163
    v_cvt_pk_bf16_f32 v86, v164, v165
    v_cvt_pk_bf16_f32 v87, v166, v167
    ds_write_b128 v188, v[84:87] offset:16512
    v_lshlrev_b32 v160, 16, v88
    v_and_b32 v161, s61, v88
    v_lshlrev_b32 v162, 16, v89
    v_and_b32 v163, s61, v89
    v_lshlrev_b32 v164, 16, v90
    v_and_b32 v165, s61, v90
    buffer_load_dwordx4 v182, s[12:15], s87 offen offset:2048 lds
    v_lshlrev_b32 v166, 16, v91
    v_and_b32 v167, s61, v91
    v_pk_fma_f32 v[160:161], v[160:161], v[176:177], v[176:177] op_sel:[0,1,0] op_sel_hi:[1,1,0]
    v_pk_fma_f32 v[162:163], v[162:163], v[176:177], v[176:177] op_sel:[0,1,0] op_sel_hi:[1,1,0]
    v_pk_fma_f32 v[164:165], v[164:165], v[176:177], v[176:177] op_sel:[0,1,0] op_sel_hi:[1,1,0]
    v_pk_fma_f32 v[166:167], v[166:167], v[176:177], v[176:177] op_sel:[0,1,0] op_sel_hi:[1,1,0]
    v_cvt_pk_bf16_f32 v88, v160, v161
    v_cvt_pk_bf16_f32 v89, v162, v163
    v_cvt_pk_bf16_f32 v90, v164, v165
    v_cvt_pk_bf16_f32 v91, v166, v167
    ds_write_b128 v188, v[88:91] offset:24576
    v_lshlrev_b32 v160, 16, v92
    v_and_b32 v161, s61, v92
    v_lshlrev_b32 v162, 16, v93
    v_and_b32 v163, s61, v93
    v_lshlrev_b32 v164, 16, v94
    v_and_b32 v165, s61, v94
    buffer_load_dwordx4 v183, s[12:15], s87 offen offset:3072 lds
    v_lshlrev_b32 v166, 16, v95
    v_and_b32 v167, s61, v95
    v_pk_fma_f32 v[160:161], v[160:161], v[178:179], v[178:179] op_sel:[0,1,0] op_sel_hi:[1,1,0]
    v_pk_fma_f32 v[162:163], v[162:163], v[178:179], v[178:179] op_sel:[0,1,0] op_sel_hi:[1,1,0]
    v_pk_fma_f32 v[164:165], v[164:165], v[178:179], v[178:179] op_sel:[0,1,0] op_sel_hi:[1,1,0]
    v_pk_fma_f32 v[166:167], v[166:167], v[178:179], v[178:179] op_sel:[0,1,0] op_sel_hi:[1,1,0]
    s_lshl2_add_u32 s64, s2, s52
    s_mul_i32 s65, s64, 4
    v_add_lshl_u32 v200, v1, s65, 7
    s_mov_b64 exec, 15
    buffer_load_dword v199, v199, s[12:15], 0 offen offset:0
    s_mov_b64 exec, 15
    buffer_load_dword v200, v200, s[16:19], 0 offen offset:0
    s_mov_b64 exec, -1
    v_cvt_pk_bf16_f32 v92, v160, v161
    v_cvt_pk_bf16_f32 v93, v162, v163
    v_cvt_pk_bf16_f32 v94, v164, v165
    v_cvt_pk_bf16_f32 v95, v166, v167
    ds_write_b128 v188, v[92:95] offset:24704
    s_waitcnt vmcnt(10)
    s_waitcnt lgkmcnt(0)
    s_barrier
    ds_read_b128 a[0:3], v189 offset:0
    ds_read_b64_tr_b16 a[128:129], v193 offset:32768
    ds_read_b64_tr_b16 a[130:131], v193 offset:33280
    ds_read_b64_tr_b16 a[132:133], v193 offset:34816
    ds_read_b64_tr_b16 a[134:135], v193 offset:35328
    ds_read_b128 a[4:7], v190 offset:1024
    ds_read_b64_tr_b16 a[136:137], v193 offset:36864
    ds_read_b64_tr_b16 a[138:139], v193 offset:37376
    ds_read_b64_tr_b16 a[140:141], v193 offset:38912
    ds_read_b64_tr_b16 a[142:143], v193 offset:39424
    s_lshr_b32 s64, s55, 2
    s_mov_b64 exec, s[100:101]
    buffer_store_dword v4, v5, s[36:39], s64 offen sc1
    s_mov_b64 exec, -1
    ds_read_b128 a[8:11], v191 offset:2048
    ds_read_b64_tr_b16 a[144:145], v193 offset:40960
    ds_read_b64_tr_b16 a[146:147], v193 offset:41472
    ds_read_b64_tr_b16 a[148:149], v193 offset:43008
    ds_read_b64_tr_b16 a[150:151], v193 offset:43520
    s_waitcnt lgkmcnt(12)
    v_mfma_f32_32x32x16_bf16 v[128:143], a[128:131], a[0:3], 0
    s_lshl_b32 s64, s59, 6
    s_add_u32 s64, s64, s63
    v_lshl_add_u32 v0, v21, 3, s64
    buffer_load_dwordx2 v[48:49], v0, s[44:47], 0 offen offset:0
    buffer_load_dwordx2 v[50:51], v0, s[44:47], 0 offen offset:16
    buffer_load_dwordx2 v[52:53], v0, s[44:47], 0 offen offset:32
    buffer_load_dwordx2 v[54:55], v0, s[44:47], 0 offen offset:48
    s_lshl_b32 s64, s81, 6
    s_add_u32 s64, s64, s62
    v_lshl_add_u32 v0, v20, 1, s64
    buffer_load_ushort v0, v0, s[40:43], 0 offen
    ds_read_b64_tr_b16 a[152:153], v193 offset:45056
    ds_read_b64_tr_b16 a[154:155], v193 offset:45568
    s_waitcnt lgkmcnt(12)
    v_mfma_f32_32x32x16_bf16 v[144:159], a[0:3], a[132:135], 0
    ds_read_b64_tr_b16 a[156:157], v193 offset:47104
    ds_read_b64_tr_b16 a[158:159], v193 offset:47616
    ds_read_b128 a[12:15], v192 offset:3072
    s_waitcnt lgkmcnt(12)
    v_mfma_f32_32x32x16_bf16 v[128:143], a[136:139], a[4:7], v[128:143]
    s_add_u32 m0, s77, 98304
    s_nop 0
    buffer_load_dwordx4 v180, s[12:15], s88 offen offset:0 lds
    ds_read_b64_tr_b16 a[128:129], v193 offset:49152
    ds_read_b64_tr_b16 a[130:131], v193 offset:49664
    s_waitcnt lgkmcnt(12)
    v_mfma_f32_32x32x16_bf16 v[144:159], a[4:7], a[140:143], v[144:159]
    ds_read_b64_tr_b16 a[132:133], v193 offset:51200
    ds_read_b64_tr_b16 a[134:135], v193 offset:51712
    ds_read_b128 a[16:19], v189 offset:8192
    s_waitcnt lgkmcnt(12)
    v_mfma_f32_32x32x16_bf16 v[128:143], a[144:147], a[8:11], v[128:143]
    buffer_load_dwordx4 v181, s[12:15], s88 offen offset:1024 lds
    ds_read_b64_tr_b16 a[136:137], v193 offset:53248
    ds_read_b64_tr_b16 a[138:139], v193 offset:53760
    s_waitcnt lgkmcnt(12)
    v_mfma_f32_32x32x16_bf16 v[144:159], a[8:11], a[148:151], v[144:159]
    ds_read_b64_tr_b16 a[140:141], v193 offset:55296
    ds_read_b64_tr_b16 a[142:143], v193 offset:55808
    ds_read_b128 a[20:23], v190 offset:9216
    s_waitcnt lgkmcnt(10)
    v_mfma_f32_32x32x16_bf16 v[128:143], a[152:155], a[12:15], v[128:143]
    buffer_load_dwordx4 v182, s[12:15], s88 offen offset:2048 lds
    ds_read_b64_tr_b16 a[144:145], v193 offset:57344
    ds_read_b64_tr_b16 a[146:147], v193 offset:57856
    v_mfma_f32_32x32x16_bf16 v[144:159], a[12:15], a[156:159], v[144:159]
    ds_read_b64_tr_b16 a[148:149], v193 offset:59392
    ds_read_b64_tr_b16 a[150:151], v193 offset:59904
    ds_read_b128 a[24:27], v191 offset:10240
    s_waitcnt lgkmcnt(10)
    v_mfma_f32_32x32x16_bf16 v[128:143], a[128:131], a[16:19], v[128:143]
    buffer_load_dwordx4 v183, s[12:15], s88 offen offset:3072 lds
    ds_read_b64_tr_b16 a[152:153], v193 offset:61440
    ds_read_b64_tr_b16 a[154:155], v193 offset:61952
    v_mfma_f32_32x32x16_bf16 v[144:159], a[16:19], a[132:135], v[144:159]
    ds_read_b64_tr_b16 a[156:157], v193 offset:63488
    ds_read_b64_tr_b16 a[158:159], v193 offset:64000
    ds_read_b128 a[28:31], v192 offset:11264
    s_waitcnt lgkmcnt(10)
    v_mfma_f32_32x32x16_bf16 v[128:143], a[136:139], a[20:23], v[128:143]
    s_waitcnt vmcnt(15)
    s_barrier
    s_add_u32 m0, s77, 114688
    s_nop 0
    buffer_load_dwordx4 v180, s[12:15], s89 offen offset:0 lds
    ds_read_b64_tr_b16 a[128:129], v194 offset:0
    ds_read_b64_tr_b16 a[130:131], v194 offset:512
    v_mfma_f32_32x32x16_bf16 v[144:159], a[20:23], a[140:143], v[144:159]
    ds_read_b64_tr_b16 a[132:133], v194 offset:2048
    ds_read_b64_tr_b16 a[134:135], v194 offset:2560
    ds_read_b128 a[32:35], v189 offset:16384
    s_waitcnt lgkmcnt(10)
    v_mfma_f32_32x32x16_bf16 v[128:143], a[144:147], a[24:27], v[128:143]
    buffer_load_dwordx4 v181, s[12:15], s89 offen offset:1024 lds
    ds_read_b64_tr_b16 a[136:137], v194 offset:4096
    ds_read_b64_tr_b16 a[138:139], v194 offset:4608
    v_mfma_f32_32x32x16_bf16 v[144:159], a[24:27], a[148:151], v[144:159]
    ds_read_b64_tr_b16 a[140:141], v194 offset:6144
    ds_read_b64_tr_b16 a[142:143], v194 offset:6656
    ds_read_b128 a[36:39], v190 offset:17408
    s_waitcnt lgkmcnt(10)
    v_mfma_f32_32x32x16_bf16 v[128:143], a[152:155], a[28:31], v[128:143]
    buffer_load_dwordx4 v182, s[12:15], s89 offen offset:2048 lds
    ds_read_b64_tr_b16 a[144:145], v194 offset:8192
    ds_read_b64_tr_b16 a[146:147], v194 offset:8704
    v_mfma_f32_32x32x16_bf16 v[144:159], a[28:31], a[156:159], v[144:159]
    ds_read_b64_tr_b16 a[148:149], v194 offset:10240
    ds_read_b64_tr_b16 a[150:151], v194 offset:10752
    ds_read_b128 a[40:43], v191 offset:18432
    s_waitcnt lgkmcnt(10)
    v_mfma_f32_32x32x16_bf16 v[128:143], a[128:131], a[32:35], v[128:143]
    buffer_load_dwordx4 v183, s[12:15], s89 offen offset:3072 lds
    ds_read_b64_tr_b16 a[152:153], v194 offset:12288
    ds_read_b64_tr_b16 a[154:155], v194 offset:12800
    v_mfma_f32_32x32x16_bf16 v[144:159], a[32:35], a[132:135], v[144:159]
    ds_read_b64_tr_b16 a[156:157], v194 offset:14336
    ds_read_b64_tr_b16 a[158:159], v194 offset:14848
    ds_read_b128 a[44:47], v192 offset:19456
    s_waitcnt lgkmcnt(10)
    v_mfma_f32_32x32x16_bf16 v[128:143], a[136:139], a[36:39], v[128:143]
    s_waitcnt vmcnt(15)
    s_barrier
    s_add_u32 m0, s77, 131072
    s_nop 0
    buffer_load_dwordx4 v180, s[12:15], s90 offen offset:0 lds
    ds_read_b64_tr_b16 a[128:129], v194 offset:16384
    ds_read_b64_tr_b16 a[130:131], v194 offset:16896
    v_mfma_f32_32x32x16_bf16 v[144:159], a[36:39], a[140:143], v[144:159]
    ds_read_b64_tr_b16 a[132:133], v194 offset:18432
    ds_read_b64_tr_b16 a[134:135], v194 offset:18944
    ds_read_b128 a[48:51], v189 offset:24576
    s_waitcnt lgkmcnt(10)
    v_mfma_f32_32x32x16_bf16 v[128:143], a[144:147], a[40:43], v[128:143]
    buffer_load_dwordx4 v181, s[12:15], s90 offen offset:1024 lds
    ds_read_b64_tr_b16 a[136:137], v194 offset:20480
    ds_read_b64_tr_b16 a[138:139], v194 offset:20992
    v_mfma_f32_32x32x16_bf16 v[144:159], a[40:43], a[148:151], v[144:159]
    ds_read_b64_tr_b16 a[140:141], v194 offset:22528
    ds_read_b64_tr_b16 a[142:143], v194 offset:23040
    ds_read_b128 a[52:55], v190 offset:25600
    s_waitcnt lgkmcnt(10)
    v_mfma_f32_32x32x16_bf16 v[128:143], a[152:155], a[44:47], v[128:143]
    buffer_load_dwordx4 v182, s[12:15], s90 offen offset:2048 lds
    ds_read_b64_tr_b16 a[144:145], v194 offset:24576
    ds_read_b64_tr_b16 a[146:147], v194 offset:25088
    v_mfma_f32_32x32x16_bf16 v[144:159], a[44:47], a[156:159], v[144:159]
    ds_read_b64_tr_b16 a[148:149], v194 offset:26624
    ds_read_b64_tr_b16 a[150:151], v194 offset:27136
    ds_read_b128 a[56:59], v191 offset:26624
    s_waitcnt lgkmcnt(10)
    v_mfma_f32_32x32x16_bf16 v[128:143], a[128:131], a[48:51], v[128:143]
    buffer_load_dwordx4 v183, s[12:15], s90 offen offset:3072 lds
    ds_read_b64_tr_b16 a[152:153], v194 offset:28672
    ds_read_b64_tr_b16 a[154:155], v194 offset:29184
    v_mfma_f32_32x32x16_bf16 v[144:159], a[48:51], a[132:135], v[144:159]
    ds_read_b64_tr_b16 a[156:157], v194 offset:30720
    ds_read_b64_tr_b16 a[158:159], v194 offset:31232
    ds_read_b128 a[60:63], v192 offset:27648
    s_waitcnt lgkmcnt(10)
    v_mfma_f32_32x32x16_bf16 v[128:143], a[136:139], a[52:55], v[128:143]
    s_add_u32 m0, s77, 147456
    s_nop 0
    buffer_load_dwordx4 v180, s[12:15], s91 offen offset:0 lds
    v_mfma_f32_32x32x16_bf16 v[144:159], a[52:55], a[140:143], v[144:159]
    s_waitcnt lgkmcnt(5)
    v_mfma_f32_32x32x16_bf16 v[128:143], a[144:147], a[56:59], v[128:143]
    buffer_load_dwordx4 v181, s[12:15], s91 offen offset:1024 lds
    v_mfma_f32_32x32x16_bf16 v[144:159], a[56:59], a[148:151], v[144:159]
    s_waitcnt lgkmcnt(0)
    v_mfma_f32_32x32x16_bf16 v[128:143], a[152:155], a[60:63], v[128:143]
    s_barrier
    buffer_load_dwordx4 v182, s[12:15], s91 offen offset:2048 lds
    v_mfma_f32_32x32x16_bf16 v[144:159], a[60:63], a[156:159], v[144:159]
    v_lshlrev_b32 v160, 16, v96
    v_and_b32 v161, s61, v96
    v_lshlrev_b32 v162, 16, v97
    v_and_b32 v163, s61, v97
    v_lshlrev_b32 v164, 16, v98
    v_and_b32 v165, s61, v98
    buffer_load_dwordx4 v183, s[12:15], s91 offen offset:3072 lds
    v_lshlrev_b32 v166, 16, v99
    v_and_b32_e64 v167, s61, v99
    v_pk_fma_f32 v[160:161], v[160:161], v[176:177], v[176:177] op_sel:[0,1,0] op_sel_hi:[1,1,0]
    v_pk_fma_f32 v[162:163], v[162:163], v[176:177], v[176:177] op_sel:[0,1,0] op_sel_hi:[1,1,0]
    v_pk_fma_f32 v[164:165], v[164:165], v[176:177], v[176:177] op_sel:[0,1,0] op_sel_hi:[1,1,0]
    v_pk_fma_f32 v[166:167], v[166:167], v[176:177], v[176:177] op_sel:[0,1,0] op_sel_hi:[1,1,0]
    v_cvt_pk_bf16_f32 v96, v160, v161
    v_cvt_pk_bf16_f32 v97, v162, v163
    v_cvt_pk_bf16_f32 v98, v164, v165
    v_cvt_pk_bf16_f32 v99, v166, v167
    ds_write_b128 v188, v[96:99] offset:0
    v_lshlrev_b32 v160, 16, v100
    v_and_b32 v161, s61, v100
    v_lshlrev_b32 v162, 16, v101
    v_and_b32 v163, s61, v101
    v_lshlrev_b32 v164, 16, v102
    v_and_b32 v165, s61, v102
    s_lshl2_add_u32 s64, s2, s52
    s_mul_i32 s65, s64, 11
    v_add_lshl_u32 v203, v1, s65, 7
    s_mov_b64 exec, 2047
    buffer_load_dword v203, v203, s[20:23], 0 offen offset:0
    s_mov_b64 exec, -1
    v_lshlrev_b32 v166, 16, v103
    v_and_b32 v167, s61, v103
    v_pk_fma_f32 v[160:161], v[160:161], v[178:179], v[178:179] op_sel:[0,1,0] op_sel_hi:[1,1,0]
    v_pk_fma_f32 v[162:163], v[162:163], v[178:179], v[178:179] op_sel:[0,1,0] op_sel_hi:[1,1,0]
    v_pk_fma_f32 v[164:165], v[164:165], v[178:179], v[178:179] op_sel:[0,1,0] op_sel_hi:[1,1,0]
    v_pk_fma_f32 v[166:167], v[166:167], v[178:179], v[178:179] op_sel:[0,1,0] op_sel_hi:[1,1,0]
    s_lshl2_add_u32 s64, s2, s52
    s_mul_i32 s65, s64, 11
    v_add_lshl_u32 v204, v1, s65, 7
    s_mov_b64 exec, 2047
    buffer_load_dword v204, v204, s[24:27], 0 offen offset:0
    s_mov_b64 exec, -1
    v_cvt_pk_bf16_f32 v100, v160, v161
    v_cvt_pk_bf16_f32 v101, v162, v163
    v_cvt_pk_bf16_f32 v102, v164, v165
    v_cvt_pk_bf16_f32 v103, v166, v167
    ds_write_b128 v188, v[100:103] offset:128
    v_lshlrev_b32 v160, 16, v104
    v_and_b32 v161, s61, v104
    v_lshlrev_b32 v162, 16, v105
    v_and_b32 v163, s61, v105
    v_lshlrev_b32 v164, 16, v106
    v_and_b32 v165, s61, v106
    v_lshlrev_b32 v166, 16, v107
    v_and_b32 v167, s61, v107
    v_pk_fma_f32 v[160:161], v[160:161], v[176:177], v[176:177] op_sel:[0,1,0] op_sel_hi:[1,1,0]
    v_pk_fma_f32 v[162:163], v[162:163], v[176:177], v[176:177] op_sel:[0,1,0] op_sel_hi:[1,1,0]
    v_pk_fma_f32 v[164:165], v[164:165], v[176:177], v[176:177] op_sel:[0,1,0] op_sel_hi:[1,1,0]
    v_pk_fma_f32 v[166:167], v[166:167], v[176:177], v[176:177] op_sel:[0,1,0] op_sel_hi:[1,1,0]
    s_add_u32 m0, s77, 32768
    s_cmp_eq_u32 s58, 0
    s_cselect_b32 s67, s84, s85
    buffer_load_dwordx4 v184, s[12:15], s67 offen offset:0 lds
    v_cvt_pk_bf16_f32 v104, v160, v161
    v_cvt_pk_bf16_f32 v105, v162, v163
    v_cvt_pk_bf16_f32 v106, v164, v165
    v_cvt_pk_bf16_f32 v107, v166, v167
    ds_write_b128 v188, v[104:107] offset:8192
    v_lshlrev_b32 v160, 16, v108
    v_and_b32 v161, s61, v108
    v_lshlrev_b32 v162, 16, v109
    v_and_b32 v163, s61, v109
    v_lshlrev_b32 v164, 16, v110
    v_and_b32 v165, s61, v110
    buffer_load_dwordx4 v185, s[12:15], s67 offen offset:1024 lds
    v_lshlrev_b32 v166, 16, v111
    v_and_b32 v167, s61, v111
    v_pk_fma_f32 v[160:161], v[160:161], v[178:179], v[178:179] op_sel:[0,1,0] op_sel_hi:[1,1,0]
    v_pk_fma_f32 v[162:163], v[162:163], v[178:179], v[178:179] op_sel:[0,1,0] op_sel_hi:[1,1,0]
    v_pk_fma_f32 v[164:165], v[164:165], v[178:179], v[178:179] op_sel:[0,1,0] op_sel_hi:[1,1,0]
    v_pk_fma_f32 v[166:167], v[166:167], v[178:179], v[178:179] op_sel:[0,1,0] op_sel_hi:[1,1,0]
    v_cvt_pk_bf16_f32 v108, v160, v161
    v_cvt_pk_bf16_f32 v109, v162, v163
    v_cvt_pk_bf16_f32 v110, v164, v165
    v_cvt_pk_bf16_f32 v111, v166, v167
    ds_write_b128 v188, v[108:111] offset:8320
    v_lshlrev_b32 v160, 16, v112
    v_and_b32 v161, s61, v112
    v_lshlrev_b32 v162, 16, v113
    v_and_b32 v163, s61, v113
    v_lshlrev_b32 v164, 16, v114
    v_and_b32 v165, s61, v114
    buffer_load_dwordx4 v186, s[12:15], s67 offen offset:2048 lds
    v_lshlrev_b32 v166, 16, v115
    v_and_b32 v167, s61, v115
    v_pk_fma_f32 v[160:161], v[160:161], v[176:177], v[176:177] op_sel:[0,1,0] op_sel_hi:[1,1,0]
    v_pk_fma_f32 v[162:163], v[162:163], v[176:177], v[176:177] op_sel:[0,1,0] op_sel_hi:[1,1,0]
    v_pk_fma_f32 v[164:165], v[164:165], v[176:177], v[176:177] op_sel:[0,1,0] op_sel_hi:[1,1,0]
    v_pk_fma_f32 v[166:167], v[166:167], v[176:177], v[176:177] op_sel:[0,1,0] op_sel_hi:[1,1,0]
    buffer_load_dwordx4 v187, s[12:15], s67 offen offset:3072 lds
    v_cvt_pk_bf16_f32 v112, v160, v161
    v_cvt_pk_bf16_f32 v113, v162, v163
    v_cvt_pk_bf16_f32 v114, v164, v165
    v_cvt_pk_bf16_f32 v115, v166, v167
    ds_write_b128 v188, v[112:115] offset:16384
    v_lshlrev_b32 v160, 16, v116
    v_and_b32 v161, s61, v116
    v_lshlrev_b32 v162, 16, v117
    v_and_b32 v163, s61, v117
    v_lshlrev_b32 v164, 16, v118
    v_and_b32 v165, s61, v118
    v_lshlrev_b32 v166, 16, v119
    v_and_b32 v167, s61, v119
    v_pk_fma_f32 v[160:161], v[160:161], v[178:179], v[178:179] op_sel:[0,1,0] op_sel_hi:[1,1,0]
    v_pk_fma_f32 v[162:163], v[162:163], v[178:179], v[178:179] op_sel:[0,1,0] op_sel_hi:[1,1,0]
    v_pk_fma_f32 v[164:165], v[164:165], v[178:179], v[178:179] op_sel:[0,1,0] op_sel_hi:[1,1,0]
    v_pk_fma_f32 v[166:167], v[166:167], v[178:179], v[178:179] op_sel:[0,1,0] op_sel_hi:[1,1,0]
    s_add_u32 m0, s77, 49152
    s_cmp_eq_u32 s58, 0
    s_cselect_b32 s67, s86, s87
    buffer_load_dwordx4 v184, s[12:15], s67 offen offset:0 lds
    v_cvt_pk_bf16_f32 v116, v160, v161
    v_cvt_pk_bf16_f32 v117, v162, v163
    v_cvt_pk_bf16_f32 v118, v164, v165
    v_cvt_pk_bf16_f32 v119, v166, v167
    ds_write_b128 v188, v[116:119] offset:16512
    v_lshlrev_b32 v160, 16, v120
    v_and_b32 v161, s61, v120
    v_lshlrev_b32 v162, 16, v121
    v_and_b32 v163, s61, v121
    v_lshlrev_b32 v164, 16, v122
    v_and_b32 v165, s61, v122
    buffer_load_dwordx4 v185, s[12:15], s67 offen offset:1024 lds
    v_lshlrev_b32 v166, 16, v123
    v_and_b32 v167, s61, v123
    v_pk_fma_f32 v[160:161], v[160:161], v[176:177], v[176:177] op_sel:[0,1,0] op_sel_hi:[1,1,0]
    v_pk_fma_f32 v[162:163], v[162:163], v[176:177], v[176:177] op_sel:[0,1,0] op_sel_hi:[1,1,0]
    v_pk_fma_f32 v[164:165], v[164:165], v[176:177], v[176:177] op_sel:[0,1,0] op_sel_hi:[1,1,0]
    v_pk_fma_f32 v[166:167], v[166:167], v[176:177], v[176:177] op_sel:[0,1,0] op_sel_hi:[1,1,0]
    v_cvt_pk_bf16_f32 v120, v160, v161
    v_cvt_pk_bf16_f32 v121, v162, v163
    v_cvt_pk_bf16_f32 v122, v164, v165
    v_cvt_pk_bf16_f32 v123, v166, v167
    ds_write_b128 v188, v[120:123] offset:24576
    v_lshlrev_b32 v160, 16, v124
    v_and_b32 v161, s61, v124
    v_lshlrev_b32 v162, 16, v125
    v_and_b32 v163, s61, v125
    v_lshlrev_b32 v164, 16, v126
    v_and_b32 v165, s61, v126
    buffer_load_dwordx4 v186, s[12:15], s67 offen offset:2048 lds
    v_lshlrev_b32 v166, 16, v127
    v_and_b32 v167, s61, v127
    v_pk_fma_f32 v[160:161], v[160:161], v[178:179], v[178:179] op_sel:[0,1,0] op_sel_hi:[1,1,0]
    v_pk_fma_f32 v[162:163], v[162:163], v[178:179], v[178:179] op_sel:[0,1,0] op_sel_hi:[1,1,0]
    v_pk_fma_f32 v[164:165], v[164:165], v[178:179], v[178:179] op_sel:[0,1,0] op_sel_hi:[1,1,0]
    v_pk_fma_f32 v[166:167], v[166:167], v[178:179], v[178:179] op_sel:[0,1,0] op_sel_hi:[1,1,0]
    v_cvt_pk_bf16_f32 v124, v160, v161
    v_cvt_pk_bf16_f32 v125, v162, v163
    v_cvt_pk_bf16_f32 v126, v164, v165
    v_cvt_pk_bf16_f32 v127, v166, v167
    ds_write_b128 v188, v[124:127] offset:24704
    s_waitcnt vmcnt(17)
    s_waitcnt lgkmcnt(0)
    s_barrier
    ds_read_b128 a[64:67], v189 offset:0
    ds_read_b64_tr_b16 a[128:129], v194 offset:32768
    ds_read_b64_tr_b16 a[130:131], v194 offset:33280
    ds_read_b64_tr_b16 a[132:133], v194 offset:34816
    ds_read_b64_tr_b16 a[134:135], v194 offset:35328
    ds_read_b128 a[68:71], v190 offset:1024
    ds_read_b64_tr_b16 a[136:137], v194 offset:36864
    ds_read_b64_tr_b16 a[138:139], v194 offset:37376
    ds_read_b64_tr_b16 a[140:141], v194 offset:38912
    ds_read_b64_tr_b16 a[142:143], v194 offset:39424
    buffer_load_dword v3, v196, s[36:39], 0 offen sc1
    ds_read_b128 a[72:75], v191 offset:2048
    ds_read_b64_tr_b16 a[144:145], v194 offset:40960
    ds_read_b64_tr_b16 a[146:147], v194 offset:41472
    ds_read_b64_tr_b16 a[148:149], v194 offset:43008
    ds_read_b64_tr_b16 a[150:151], v194 offset:43520
    s_waitcnt lgkmcnt(12)
    v_mfma_f32_32x32x16_bf16 v[128:143], a[128:131], a[64:67], v[128:143]
    buffer_load_dwordx4 v187, s[12:15], s67 offen offset:3072 lds
    ds_read_b64_tr_b16 a[152:153], v194 offset:45056
    ds_read_b64_tr_b16 a[154:155], v194 offset:45568
    s_waitcnt lgkmcnt(12)
    v_mfma_f32_32x32x16_bf16 v[144:159], a[64:67], a[132:135], v[144:159]
    ds_read_b64_tr_b16 a[156:157], v194 offset:47104
    ds_read_b64_tr_b16 a[158:159], v194 offset:47616
    ds_read_b128 a[76:79], v192 offset:3072
    s_waitcnt lgkmcnt(12)
    v_mfma_f32_32x32x16_bf16 v[128:143], a[136:139], a[68:71], v[128:143]
    s_add_u32 m0, s77, 65536
    s_cmp_eq_u32 s58, 0
    s_cselect_b32 s67, s88, s89
    buffer_load_dwordx4 v184, s[12:15], s67 offen offset:0 lds
    ds_read_b64_tr_b16 a[128:129], v194 offset:49152
    ds_read_b64_tr_b16 a[130:131], v194 offset:49664
    s_waitcnt lgkmcnt(12)
    v_mfma_f32_32x32x16_bf16 v[144:159], a[68:71], a[140:143], v[144:159]
    ds_read_b64_tr_b16 a[132:133], v194 offset:51200
    ds_read_b64_tr_b16 a[134:135], v194 offset:51712
    ds_read_b128 a[80:83], v189 offset:8192
    s_waitcnt lgkmcnt(12)
    v_mfma_f32_32x32x16_bf16 v[128:143], a[144:147], a[72:75], v[128:143]
    buffer_load_dwordx4 v185, s[12:15], s67 offen offset:1024 lds
    ds_read_b64_tr_b16 a[136:137], v194 offset:53248
    ds_read_b64_tr_b16 a[138:139], v194 offset:53760
    s_waitcnt lgkmcnt(12)
    v_mfma_f32_32x32x16_bf16 v[144:159], a[72:75], a[148:151], v[144:159]
    ds_read_b64_tr_b16 a[140:141], v194 offset:55296
    ds_read_b64_tr_b16 a[142:143], v194 offset:55808
    ds_read_b128 a[84:87], v190 offset:9216
    s_waitcnt lgkmcnt(10)
    v_mfma_f32_32x32x16_bf16 v[128:143], a[152:155], a[76:79], v[128:143]
    buffer_load_dwordx4 v186, s[12:15], s67 offen offset:2048 lds
    ds_read_b64_tr_b16 a[144:145], v194 offset:57344
    ds_read_b64_tr_b16 a[146:147], v194 offset:57856
    v_mfma_f32_32x32x16_bf16 v[144:159], a[76:79], a[156:159], v[144:159]
    ds_read_b64_tr_b16 a[148:149], v194 offset:59392
    ds_read_b64_tr_b16 a[150:151], v194 offset:59904
    ds_read_b128 a[88:91], v191 offset:10240
    s_waitcnt lgkmcnt(10)
    v_mfma_f32_32x32x16_bf16 v[128:143], a[128:131], a[80:83], v[128:143]
    buffer_load_dwordx4 v187, s[12:15], s67 offen offset:3072 lds
    ds_read_b64_tr_b16 a[152:153], v194 offset:61440
    ds_read_b64_tr_b16 a[154:155], v194 offset:61952
    v_mfma_f32_32x32x16_bf16 v[144:159], a[80:83], a[132:135], v[144:159]
    ds_read_b64_tr_b16 a[156:157], v194 offset:63488
    ds_read_b64_tr_b16 a[158:159], v194 offset:64000
    ds_read_b128 a[92:95], v192 offset:11264
    s_waitcnt lgkmcnt(10)
    v_mfma_f32_32x32x16_bf16 v[128:143], a[136:139], a[84:87], v[128:143]
    s_waitcnt vmcnt(19)
    s_barrier
    s_add_u32 m0, s77, 81920
    s_cmp_eq_u32 s58, 0
    s_cselect_b32 s67, s90, s91
    buffer_load_dwordx4 v184, s[12:15], s67 offen offset:0 lds
    ds_read_b64_tr_b16 a[128:129], v195 offset:0
    ds_read_b64_tr_b16 a[130:131], v195 offset:512
    v_mfma_f32_32x32x16_bf16 v[144:159], a[84:87], a[140:143], v[144:159]
    ds_read_b64_tr_b16 a[132:133], v195 offset:2048
    ds_read_b64_tr_b16 a[134:135], v195 offset:2560
    ds_read_b128 a[96:99], v189 offset:16384
    s_waitcnt lgkmcnt(10)
    v_mfma_f32_32x32x16_bf16 v[128:143], a[144:147], a[88:91], v[128:143]
    buffer_load_dwordx4 v185, s[12:15], s67 offen offset:1024 lds
    ds_read_b64_tr_b16 a[136:137], v195 offset:4096
    ds_read_b64_tr_b16 a[138:139], v195 offset:4608
    v_mfma_f32_32x32x16_bf16 v[144:159], a[88:91], a[148:151], v[144:159]
    ds_read_b64_tr_b16 a[140:141], v195 offset:6144
    ds_read_b64_tr_b16 a[142:143], v195 offset:6656
    ds_read_b128 a[100:103], v190 offset:17408
    s_waitcnt lgkmcnt(10)
    v_mfma_f32_32x32x16_bf16 v[128:143], a[152:155], a[92:95], v[128:143]
    buffer_load_dwordx4 v186, s[12:15], s67 offen offset:2048 lds
    ds_read_b64_tr_b16 a[144:145], v195 offset:8192
    ds_read_b64_tr_b16 a[146:147], v195 offset:8704
    v_mfma_f32_32x32x16_bf16 v[144:159], a[92:95], a[156:159], v[144:159]
    ds_read_b64_tr_b16 a[148:149], v195 offset:10240
    ds_read_b64_tr_b16 a[150:151], v195 offset:10752
    ds_read_b128 a[104:107], v191 offset:18432
    s_waitcnt lgkmcnt(10)
    v_mfma_f32_32x32x16_bf16 v[128:143], a[128:131], a[96:99], v[128:143]
    buffer_load_dwordx4 v187, s[12:15], s67 offen offset:3072 lds
    ds_read_b64_tr_b16 a[152:153], v195 offset:12288
    ds_read_b64_tr_b16 a[154:155], v195 offset:12800
    v_mfma_f32_32x32x16_bf16 v[144:159], a[96:99], a[132:135], v[144:159]
    ds_read_b64_tr_b16 a[156:157], v195 offset:14336
    ds_read_b64_tr_b16 a[158:159], v195 offset:14848
    ds_read_b128 a[108:111], v192 offset:19456
    s_waitcnt lgkmcnt(10)
    v_mfma_f32_32x32x16_bf16 v[128:143], a[136:139], a[100:103], v[128:143]
    s_waitcnt vmcnt(19)
    s_barrier
    ds_read_b64_tr_b16 a[128:129], v195 offset:16384
    ds_read_b64_tr_b16 a[130:131], v195 offset:16896
    v_mfma_f32_32x32x16_bf16 v[144:159], a[100:103], a[140:143], v[144:159]
    ds_read_b64_tr_b16 a[132:133], v195 offset:18432
    ds_read_b64_tr_b16 a[134:135], v195 offset:18944
    ds_read_b128 a[112:115], v189 offset:24576
    s_waitcnt lgkmcnt(10)
    v_mfma_f32_32x32x16_bf16 v[128:143], a[144:147], a[104:107], v[128:143]
    ds_read_b64_tr_b16 a[136:137], v195 offset:20480
    ds_read_b64_tr_b16 a[138:139], v195 offset:20992
    v_mfma_f32_32x32x16_bf16 v[144:159], a[104:107], a[148:151], v[144:159]
    ds_read_b64_tr_b16 a[140:141], v195 offset:22528
    ds_read_b64_tr_b16 a[142:143], v195 offset:23040
    ds_read_b128 a[116:119], v190 offset:25600
    s_waitcnt lgkmcnt(10)
    v_mfma_f32_32x32x16_bf16 v[128:143], a[152:155], a[108:111], v[128:143]
    ds_read_b64_tr_b16 a[144:145], v195 offset:24576
    ds_read_b64_tr_b16 a[146:147], v195 offset:25088
    v_mfma_f32_32x32x16_bf16 v[144:159], a[108:111], a[156:159], v[144:159]
    ds_read_b64_tr_b16 a[148:149], v195 offset:26624
    ds_read_b64_tr_b16 a[150:151], v195 offset:27136
    ds_read_b128 a[120:123], v191 offset:26624
    s_waitcnt lgkmcnt(10)
    v_mfma_f32_32x32x16_bf16 v[128:143], a[128:131], a[112:115], v[128:143]
    ds_read_b64_tr_b16 a[152:153], v195 offset:28672
    ds_read_b64_tr_b16 a[154:155], v195 offset:29184
    v_mfma_f32_32x32x16_bf16 v[144:159], a[112:115], a[132:135], v[144:159]
    ds_read_b64_tr_b16 a[156:157], v195 offset:30720
    ds_read_b64_tr_b16 a[158:159], v195 offset:31232
    ds_read_b128 a[124:127], v192 offset:27648
    s_waitcnt lgkmcnt(10)
    v_mfma_f32_32x32x16_bf16 v[128:143], a[136:139], a[116:119], v[128:143]
    s_waitcnt vmcnt(8)
    s_barrier
    ds_read_b64_tr_b16 a[128:129], v193 offset:32768
    ds_read_b64_tr_b16 a[130:131], v193 offset:33280
    v_mfma_f32_32x32x16_bf16 v[144:159], a[116:119], a[140:143], v[144:159]
    ds_read_b64_tr_b16 a[132:133], v193 offset:34816
    ds_read_b64_tr_b16 a[134:135], v193 offset:35328
    s_waitcnt lgkmcnt(9)
    v_mfma_f32_32x32x16_bf16 v[128:143], a[144:147], a[120:123], v[128:143]
    ds_read_b64_tr_b16 a[136:137], v193 offset:36864
    ds_read_b64_tr_b16 a[138:139], v193 offset:37376
    v_mfma_f32_32x32x16_bf16 v[144:159], a[120:123], a[148:151], v[144:159]
    ds_read_b64_tr_b16 a[140:141], v193 offset:38912
    ds_read_b64_tr_b16 a[142:143], v193 offset:39424
    s_waitcnt lgkmcnt(8)
    v_mfma_f32_32x32x16_bf16 v[128:143], a[152:155], a[124:127], v[128:143]
    ds_read_b64_tr_b16 a[144:145], v193 offset:40960
    ds_read_b64_tr_b16 a[146:147], v193 offset:41472
    v_mfma_f32_32x32x16_bf16 v[144:159], a[124:127], a[156:159], v[144:159]
    ds_read_b64_tr_b16 a[148:149], v193 offset:43008
    ds_read_b64_tr_b16 a[150:151], v193 offset:43520
    s_waitcnt lgkmcnt(10)
    v_mfma_f32_32x32x16_bf16 v[160:175], a[128:131], a[0:3], 0
    s_nop 4
    v_cvt_pk_bf16_f32 v80, v128, v129
    v_cvt_pk_bf16_f32 v81, v130, v131
    v_cvt_pk_bf16_f32 v82, v132, v133
    v_cvt_pk_bf16_f32 v83, v134, v135
    s_waitcnt lgkmcnt(8)
    v_mfma_f32_32x32x16_bf16 v[160:175], a[132:135], a[4:7], v[160:175]
    buffer_store_dwordx4 v[80:83], v2, s[32:35], s92 offen offset:0 sc1
    v_cvt_pk_bf16_f32 v84, v136, v137
    v_cvt_pk_bf16_f32 v85, v138, v139
    v_cvt_pk_bf16_f32 v86, v140, v141
    v_cvt_pk_bf16_f32 v87, v142, v143
    s_waitcnt lgkmcnt(6)
    v_mfma_f32_32x32x16_bf16 v[160:175], a[136:139], a[8:11], v[160:175]
    buffer_store_dwordx4 v[84:87], v2, s[32:35], s92 offen offset:2048 sc1
    v_cvt_pk_bf16_f32 v88, v144, v145
    v_cvt_pk_bf16_f32 v89, v146, v147
    v_cvt_pk_bf16_f32 v90, v148, v149
    v_cvt_pk_bf16_f32 v91, v150, v151
    s_waitcnt lgkmcnt(4)
    v_mfma_f32_32x32x16_bf16 v[160:175], a[140:143], a[12:15], v[160:175]
    ds_read_b64_tr_b16 a[152:153], v193 offset:45056
    ds_read_b64_tr_b16 a[154:155], v193 offset:45568
    buffer_store_dwordx4 v[88:91], v240, s[32:35], s92 offen offset:1024 sc1
    v_cvt_pk_bf16_f32 v92, v152, v153
    v_cvt_pk_bf16_f32 v93, v154, v155
    v_cvt_pk_bf16_f32 v94, v156, v157
    v_cvt_pk_bf16_f32 v95, v158, v159
    s_waitcnt lgkmcnt(4)
    v_mfma_f32_32x32x16_bf16 v[160:175], a[144:147], a[16:19], v[160:175]
    ds_read_b64_tr_b16 a[156:157], v193 offset:47104
    ds_read_b64_tr_b16 a[158:159], v193 offset:47616
    buffer_store_dwordx4 v[92:95], v240, s[32:35], s92 offen offset:1536 sc1
    s_waitcnt lgkmcnt(4)
    v_mfma_f32_32x32x16_bf16 v[160:175], a[148:151], a[20:23], v[160:175]
    ds_read_b64_tr_b16 a[128:129], v193 offset:49152
    ds_read_b64_tr_b16 a[130:131], v193 offset:49664
    ds_read_b64_tr_b16 a[132:133], v193 offset:51200
    ds_read_b64_tr_b16 a[134:135], v193 offset:51712
    s_waitcnt lgkmcnt(6)
    v_mfma_f32_32x32x16_bf16 v[160:175], a[152:155], a[24:27], v[160:175]
    s_waitcnt vmcnt(4)
    s_barrier
    ds_read_b64_tr_b16 a[136:137], v193 offset:53248
    ds_read_b64_tr_b16 a[138:139], v193 offset:53760
    ds_read_b64_tr_b16 a[140:141], v193 offset:55296
    ds_read_b64_tr_b16 a[142:143], v193 offset:55808
    s_waitcnt lgkmcnt(8)
    v_mfma_f32_32x32x16_bf16 v[160:175], a[156:159], a[28:31], v[160:175]
    ds_write_b128 v241, v[80:83] offset:1024
    s_waitcnt lgkmcnt(7)
    v_mfma_f32_32x32x16_bf16 v[160:175], a[128:131], a[32:35], v[160:175]
    ds_read_b64_tr_b16 a[144:145], v193 offset:57344
    ds_read_b64_tr_b16 a[146:147], v193 offset:57856
    ds_read_b64_tr_b16 a[148:149], v193 offset:59392
    ds_read_b64_tr_b16 a[150:151], v193 offset:59904
    s_waitcnt lgkmcnt(9)
    v_mfma_f32_32x32x16_bf16 v[160:175], a[132:135], a[36:39], v[160:175]
    ds_write_b128 v241, v[84:87] offset:4096
    s_waitcnt lgkmcnt(8)
    v_mfma_f32_32x32x16_bf16 v[160:175], a[136:139], a[40:43], v[160:175]
    ds_read_b64_tr_b16 a[152:153], v193 offset:61440
    ds_read_b64_tr_b16 a[154:155], v193 offset:61952
    ds_read_b64_tr_b16 a[156:157], v193 offset:63488
    ds_read_b64_tr_b16 a[158:159], v193 offset:64000
    s_waitcnt lgkmcnt(10)
    v_mfma_f32_32x32x16_bf16 v[160:175], a[140:143], a[44:47], v[160:175]
    ds_write_b128 v242, v[88:91] offset:2048
    s_waitcnt lgkmcnt(8)
    v_mfma_f32_32x32x16_bf16 v[160:175], a[144:147], a[48:51], v[160:175]
    ds_read_b64_tr_b16 a[128:129], v194 offset:0
    ds_read_b64_tr_b16 a[130:131], v194 offset:512
    ds_read_b64_tr_b16 a[132:133], v194 offset:2048
    ds_read_b64_tr_b16 a[134:135], v194 offset:2560
    s_waitcnt lgkmcnt(10)
    v_mfma_f32_32x32x16_bf16 v[160:175], a[148:151], a[52:55], v[160:175]
    ds_write_b128 v242, v[92:95] offset:2560
    s_waitcnt lgkmcnt(8)
    v_mfma_f32_32x32x16_bf16 v[160:175], a[152:155], a[56:59], v[160:175]
    ds_read_b64_tr_b16 a[136:137], v194 offset:4096
    ds_read_b64_tr_b16 a[138:139], v194 offset:4608
    ds_read_b64_tr_b16 a[140:141], v194 offset:6144
    ds_read_b64_tr_b16 a[142:143], v194 offset:6656
    s_waitcnt lgkmcnt(10)
    v_mfma_f32_32x32x16_bf16 v[160:175], a[156:159], a[60:63], v[160:175]
    ds_write_b128 v243, v[64:67] offset:24576
    s_waitcnt lgkmcnt(8)
    v_mfma_f32_32x32x16_bf16 v[160:175], a[128:131], a[64:67], v[160:175]
    ds_read_b64_tr_b16 a[144:145], v194 offset:8192
    ds_read_b64_tr_b16 a[146:147], v194 offset:8704
    ds_read_b64_tr_b16 a[148:149], v194 offset:10240
    ds_read_b64_tr_b16 a[150:151], v194 offset:10752
    s_waitcnt lgkmcnt(10)
    v_mfma_f32_32x32x16_bf16 v[160:175], a[132:135], a[68:71], v[160:175]
    ds_write_b128 v244, v[68:71] offset:25600
    s_waitcnt lgkmcnt(8)
    v_mfma_f32_32x32x16_bf16 v[160:175], a[136:139], a[72:75], v[160:175]
    s_barrier
    ds_read_b64_tr_b16 a[152:153], v194 offset:12288
    ds_read_b64_tr_b16 a[154:155], v194 offset:12800
    ds_read_b64_tr_b16 a[156:157], v194 offset:14336
    ds_read_b64_tr_b16 a[158:159], v194 offset:14848
    s_waitcnt lgkmcnt(10)
    v_mfma_f32_32x32x16_bf16 v[160:175], a[140:143], a[76:79], v[160:175]
    s_add_u32 m0, s77, 98304
    s_lshl3_add_u32 s67, s77, 0
    buffer_load_dwordx4 v12, s[16:19], s67 offen offset:0 lds
    s_waitcnt lgkmcnt(7)
    v_mfma_f32_32x32x16_bf16 v[160:175], a[144:147], a[80:83], v[160:175]
    ds_read_b64_tr_b16 a[128:129], v194 offset:16384
    ds_read_b64_tr_b16 a[130:131], v194 offset:16896
    ds_read_b64_tr_b16 a[132:133], v194 offset:18432
    ds_read_b64_tr_b16 a[134:135], v194 offset:18944
    s_waitcnt lgkmcnt(9)
    v_mfma_f32_32x32x16_bf16 v[160:175], a[148:151], a[84:87], v[160:175]
    buffer_load_dwordx4 v13, s[16:19], s67 offen offset:1024 lds
    s_waitcnt lgkmcnt(6)
    v_mfma_f32_32x32x16_bf16 v[160:175], a[152:155], a[88:91], v[160:175]
    ds_read_b64_tr_b16 a[136:137], v194 offset:20480
    ds_read_b64_tr_b16 a[138:139], v194 offset:20992
    ds_read_b64_tr_b16 a[140:141], v194 offset:22528
    ds_read_b64_tr_b16 a[142:143], v194 offset:23040
    s_waitcnt lgkmcnt(8)
    v_mfma_f32_32x32x16_bf16 v[160:175], a[156:159], a[92:95], v[160:175]
    buffer_load_dwordx4 v14, s[16:19], s67 offen offset:2048 lds
    s_waitcnt lgkmcnt(6)
    v_mfma_f32_32x32x16_bf16 v[160:175], a[128:131], a[96:99], v[160:175]
    ds_read_b64_tr_b16 a[144:145], v194 offset:24576
    ds_read_b64_tr_b16 a[146:147], v194 offset:25088
    ds_read_b64_tr_b16 a[148:149], v194 offset:26624
    ds_read_b64_tr_b16 a[150:151], v194 offset:27136
    s_mov_b32 s78, 0x3eb8aa3b
    s_lshl_b32 s66, s93, 11
    s_add_u32 s66, s66, 524288
    s_lshl_b32 s92, s93, 10
    s_waitcnt lgkmcnt(8)
    v_mfma_f32_32x32x16_bf16 v[160:175], a[132:135], a[100:103], v[160:175]
    buffer_load_dwordx4 v15, s[16:19], s67 offen offset:3072 lds
    s_waitcnt lgkmcnt(6)
    v_mfma_f32_32x32x16_bf16 v[160:175], a[136:139], a[104:107], v[160:175]
    ds_read_b64_tr_b16 a[152:153], v194 offset:28672
    ds_read_b64_tr_b16 a[154:155], v194 offset:29184
    ds_read_b64_tr_b16 a[156:157], v194 offset:30720
    ds_read_b64_tr_b16 a[158:159], v194 offset:31232
    s_add_u32 s92, s92, 5242880
    s_add_u32 s93, s92, 32768
    s_mul_i32 s87, s52, 98304
    s_lshl_b32 s88, s52, 16
    s_waitcnt lgkmcnt(8)
    v_mfma_f32_32x32x16_bf16 v[160:175], a[140:143], a[108:111], v[160:175]
    s_add_u32 m0, s77, 114688
    s_lshl3_add_u32 s67, s77, 262144
    buffer_load_dwordx4 v12, s[16:19], s67 offen offset:0 lds
    s_waitcnt lgkmcnt(6)
    v_mfma_f32_32x32x16_bf16 v[160:175], a[144:147], a[112:115], v[160:175]
    s_and_b32 s84, s69, 0xffffff80
    s_lshl_b32 s64, s59, 6
    s_add_u32 s84, s84, s64
    s_lshl2_add_u32 s64, s54, s52
    s_waitcnt lgkmcnt(4)
    v_mfma_f32_32x32x16_bf16 v[160:175], a[148:151], a[116:119], v[160:175]
    v_cmp_gt_u32 vcc, 1, v3
    s_cbranch_vccnz L_ap1_s
L_ap1_r:
    s_waitcnt vmcnt(5)
    s_barrier
    s_mov_b64 exec, s[98:99]
    buffer_store_dword v4, v5, s[32:35], s68 offen sc1
    s_mov_b64 exec, -1
    buffer_load_dwordx4 v13, s[16:19], s67 offen offset:1024 lds
    s_waitcnt lgkmcnt(2)
    v_mfma_f32_32x32x16_bf16 v[160:175], a[152:155], a[120:123], v[160:175]
    s_lshl_b32 s90, s64, 14
    s_add_u32 s90, s90, 5242880
    s_mul_i32 s91, s64, 45056
    s_add_u32 s91, s91, 9437184
    s_waitcnt lgkmcnt(0)
    v_mfma_f32_32x32x16_bf16 v[160:175], a[156:159], a[124:127], v[160:175]
    buffer_load_dwordx4 v14, s[16:19], s67 offen offset:2048 lds
    buffer_load_dwordx4 v15, s[16:19], s67 offen offset:3072 lds
    s_add_u32 m0, s77, 131072
    s_lshl3_add_u32 s67, s77, 131072
    buffer_load_dwordx4 v12, s[16:19], s67 offen offset:0 lds
    s_nop 6
    s_nop 0
    v_pk_mul_f32 v[160:161], v[160:161], s[78:79] op_sel_hi:[1,0]
    v_pk_mul_f32 v[162:163], v[162:163], s[78:79] op_sel_hi:[1,0]
    v_pk_mul_f32 v[164:165], v[164:165], s[78:79] op_sel_hi:[1,0]
    v_pk_mul_f32 v[166:167], v[166:167], s[78:79] op_sel_hi:[1,0]
    v_cvt_pk_bf16_f32 v80, v160, v161
    v_cvt_pk_bf16_f32 v81, v162, v163
    v_cvt_pk_bf16_f32 v82, v164, v165
    v_cvt_pk_bf16_f32 v83, v166, v167
    ds_write_b128 v241, v[80:83] offset:0
    buffer_load_dwordx4 v13, s[16:19], s67 offen offset:1024 lds
    buffer_load_dwordx4 v14, s[16:19], s67 offen offset:2048 lds
    v_pk_mul_f32 v[168:169], v[168:169], s[78:79] op_sel_hi:[1,0]
    v_pk_mul_f32 v[170:171], v[170:171], s[78:79] op_sel_hi:[1,0]
    v_pk_mul_f32 v[172:173], v[172:173], s[78:79] op_sel_hi:[1,0]
    v_pk_mul_f32 v[174:175], v[174:175], s[78:79] op_sel_hi:[1,0]
    v_cvt_pk_bf16_f32 v84, v168, v169
    v_cvt_pk_bf16_f32 v85, v170, v171
    v_cvt_pk_bf16_f32 v86, v172, v173
    v_cvt_pk_bf16_f32 v87, v174, v175
    ds_write_b128 v241, v[84:87] offset:3072
    buffer_load_dwordx4 v15, s[16:19], s67 offen offset:3072 lds
    s_add_u32 m0, s77, 147456
    s_lshl3_add_u32 s67, s77, 393216
    buffer_load_dwordx4 v12, s[16:19], s67 offen offset:0 lds
    buffer_load_dwordx4 v13, s[16:19], s67 offen offset:1024 lds
    s_waitcnt lgkmcnt(0)
    s_barrier
    ds_read_b128 a[248:251], v245 offset:0
    ds_read_b128 a[240:243], v245 offset:1024
    ds_read_b128 a[252:255], v245 offset:12288
    ds_read_b128 a[244:247], v245 offset:13312
    s_mov_b64 exec, s[96:97]
    ds_read_b128 a[224:227], v246 offset:2048
    ds_read_b128 a[228:231], v246 offset:2560
    ds_read_b128 a[232:235], v246 offset:14336
    ds_read_b128 a[236:239], v246 offset:14848
    s_mov_b64 exec, -1
    ds_read_b64 v[160:161], v248 offset:24576
    ds_read_b64 v[162:163], v249 offset:24576
    ds_read_b64 v[164:165], v250 offset:24576
    ds_read_b64 v[166:167], v251 offset:24576
    buffer_load_dwordx4 v14, s[16:19], s67 offen offset:2048 lds
    buffer_load_dwordx4 v15, s[16:19], s67 offen offset:3072 lds
    buffer_load_dword v3, v197, s[32:35], 0 offen sc1
    v_mov_b32 v4, 1
    s_mov_b32 s78, 0x1f800000
    v_min_u32 v78, 5, v1
    v_lshlrev_b32 v78, 7, v78
    s_waitcnt lgkmcnt(0)
    v_mfma_f32_32x32x16_bf16 v[80:95], a[240:243], a[248:251], v[208:223]
    s_mov_b32 s72, 0
L_bp2:
    s_waitcnt vmcnt(0)
    v_cmp_gt_u32 vcc, 1, v3
    s_add_u32 s72, s72, 1
    s_bitcmp1_b32 s72, 20
    buffer_load_dword v3, v197, s[32:35], 0 offen sc1
    s_cbranch_scc1 L_bp2_x
    s_cbranch_vccnz L_bp2
L_bp2_x:
    s_mov_b32 s50, s76
    s_add_u32 s65, s66, 458752
    buffer_load_dwordx4 v[204:207], v2, s[48:51], s65 offen sc1
    s_mov_b64 exec, s[96:97]
    buffer_load_dwordx4 a[216:219], v35, s[48:51], s65 offen offset:1024 sc1
    buffer_load_dwordx4 a[220:223], v35, s[48:51], s65 offen offset:1536 sc1
    s_mov_b64 exec, -1
    s_add_u32 s65, s66, 393216
    buffer_load_dwordx4 v[200:203], v2, s[48:51], s65 offen sc1
    s_barrier
    v_exp_f32 v80, v80
    v_exp_f32 v81, v81
    v_exp_f32 v82, v82
    v_exp_f32 v83, v83
    v_exp_f32 v84, v84
    v_exp_f32 v85, v85
    v_mfma_f32_32x32x16_bf16 v[96:111], a[240:243], a[252:255], 0
    s_mov_b64 exec, s[96:97]
    buffer_load_dwordx4 a[208:211], v35, s[48:51], s65 offen offset:1024 sc1
    buffer_load_dwordx4 a[212:215], v35, s[48:51], s65 offen offset:1536 sc1
    s_mov_b64 exec, -1
    ds_read_b64_tr_b16 a[0:1], v32 offset:0
    ds_read_b64_tr_b16 a[2:3], v32 offset:1024
    ds_read_b64_tr_b16 a[4:5], v33 offset:0
    ds_read_b64_tr_b16 a[6:7], v33 offset:1024
    v_exp_f32 v86, v86
    v_exp_f32 v87, v87
    v_exp_f32 v88, v88
    v_cvt_pk_bf16_f32 v112, v80, v81
    v_cvt_pk_bf16_f32 v113, v82, v83
    v_cvt_pk_bf16_f32 v114, v84, v85
    v_cvt_pk_bf16_f32 v115, v86, v87
    v_exp_f32 v89, v89
    v_exp_f32 v90, v90
    v_mfma_f32_32x32x16_bf16 v[128:143], a[224:227], v[112:115], 0
    s_mov_b32 s50, s75
    s_add_u32 s65, s66, 327680
    buffer_load_dwordx4 v[196:199], v2, s[48:51], s65 offen sc1
    ds_read_b64_tr_b16 a[8:9], v32 offset:2048
    ds_read_b64_tr_b16 a[10:11], v32 offset:3072
    ds_read_b64_tr_b16 a[12:13], v33 offset:2048
    ds_read_b64_tr_b16 a[14:15], v33 offset:3072
    v_exp_f32 v91, v91
    v_exp_f32 v92, v92
    v_exp_f32 v93, v93
    v_exp_f32 v94, v94
    v_exp_f32 v95, v95
    v_cvt_pk_bf16_f32 v116, v88, v89
    v_cvt_pk_bf16_f32 v117, v90, v91
    v_cvt_pk_bf16_f32 v118, v92, v93
    v_cvt_pk_bf16_f32 v119, v94, v95
    v_exp_f32 v96, v96
    v_exp_f32 v97, v97
    v_mfma_f32_32x32x16_bf16 v[128:143], a[228:231], v[116:119], v[128:143]
    s_mov_b64 exec, s[96:97]
    buffer_load_dwordx4 a[200:203], v35, s[48:51], s65 offen offset:1024 sc1
    buffer_load_dwordx4 a[204:207], v35, s[48:51], s65 offen offset:1536 sc1
    s_mov_b64 exec, -1
    ds_read_b64_tr_b16 a[16:17], v32 offset:4096
    ds_read_b64_tr_b16 a[18:19], v32 offset:5120
    ds_read_b64_tr_b16 a[20:21], v33 offset:4096
    ds_read_b64_tr_b16 a[22:23], v33 offset:5120
    v_exp_f32 v98, v98
    v_exp_f32 v99, v99
    v_exp_f32 v100, v100
    v_exp_f32 v101, v101
    v_mfma_f32_32x32x16_bf16 v[80:95], a[244:247], a[252:255], v[208:223]
    s_add_u32 s65, s66, 262144
    buffer_load_dwordx4 v[192:195], v2, s[48:51], s65 offen sc1
    ds_read_b64_tr_b16 a[24:25], v32 offset:6144
    ds_read_b64_tr_b16 a[26:27], v32 offset:7168
    ds_read_b64_tr_b16 a[28:29], v33 offset:6144
    ds_read_b64_tr_b16 a[30:31], v33 offset:7168
    v_exp_f32 v102, v102
    v_exp_f32 v103, v103
    v_exp_f32 v104, v104
    v_cvt_pk_bf16_f32 v120, v96, v97
    v_cvt_pk_bf16_f32 v121, v98, v99
    v_cvt_pk_bf16_f32 v122, v100, v101
    v_cvt_pk_bf16_f32 v123, v102, v103
    v_exp_f32 v105, v105
    v_exp_f32 v106, v106
    v_mfma_f32_32x32x16_bf16 v[144:159], a[224:227], v[120:123], 0
    s_mov_b64 exec, s[96:97]
    buffer_load_dwordx4 a[192:195], v35, s[48:51], s65 offen offset:1024 sc1
    buffer_load_dwordx4 a[196:199], v35, s[48:51], s65 offen offset:1536 sc1
    s_mov_b64 exec, -1
    ds_read_b64_tr_b16 a[32:33], v32 offset:8192
    ds_read_b64_tr_b16 a[34:35], v32 offset:9216
    ds_read_b64_tr_b16 a[36:37], v33 offset:8192
    ds_read_b64_tr_b16 a[38:39], v33 offset:9216
    v_exp_f32 v107, v107
    v_exp_f32 v108, v108
    v_exp_f32 v109, v109
    v_exp_f32 v110, v110
    v_exp_f32 v111, v111
    v_cvt_pk_bf16_f32 v124, v104, v105
    v_cvt_pk_bf16_f32 v125, v106, v107
    v_cvt_pk_bf16_f32 v126, v108, v109
    v_cvt_pk_bf16_f32 v127, v110, v111
    v_exp_f32 v80, v80
    v_exp_f32 v81, v81
    v_mfma_f32_32x32x16_bf16 v[144:159], a[228:231], v[124:127], v[144:159]
    s_mov_b32 s50, s74
    s_add_u32 s65, s66, 196608
    buffer_load_dwordx4 v[188:191], v2, s[48:51], s65 offen sc1
    ds_read_b64_tr_b16 a[40:41], v32 offset:10240
    ds_read_b64_tr_b16 a[42:43], v32 offset:11264
    ds_read_b64_tr_b16 a[44:45], v33 offset:10240
    ds_read_b64_tr_b16 a[46:47], v33 offset:11264
    v_exp_f32 v82, v82
    v_exp_f32 v83, v83
    v_exp_f32 v84, v84
    v_exp_f32 v85, v85
    s_waitcnt vmcnt(12)
    v_mfma_f32_32x32x16_bf16 v[96:111], v[204:207], a[248:251], 0
    s_mov_b64 exec, s[96:97]
    buffer_load_dwordx4 a[184:187], v35, s[48:51], s65 offen offset:1024 sc1
    buffer_load_dwordx4 a[188:191], v35, s[48:51], s65 offen offset:1536 sc1
    s_mov_b64 exec, -1
    ds_read_b64_tr_b16 a[48:49], v32 offset:12288
    ds_read_b64_tr_b16 a[50:51], v32 offset:13312
    ds_read_b64_tr_b16 a[52:53], v33 offset:12288
    ds_read_b64_tr_b16 a[54:55], v33 offset:13312
    v_exp_f32 v86, v86
    v_exp_f32 v87, v87
    v_exp_f32 v88, v88
    v_cvt_pk_bf16_f32 v112, v80, v81
    v_cvt_pk_bf16_f32 v113, v82, v83
    v_cvt_pk_bf16_f32 v114, v84, v85
    v_cvt_pk_bf16_f32 v115, v86, v87
    v_exp_f32 v89, v89
    v_exp_f32 v90, v90
    v_mfma_f32_32x32x16_bf16 v[144:159], a[232:235], v[112:115], v[144:159]
    s_add_u32 s65, s66, 131072
    buffer_load_dwordx4 v[184:187], v2, s[48:51], s65 offen sc1
    ds_read_b64_tr_b16 a[56:57], v32 offset:14336
    ds_read_b64_tr_b16 a[58:59], v32 offset:15360
    ds_read_b64_tr_b16 a[60:61], v33 offset:14336
    ds_read_b64_tr_b16 a[62:63], v33 offset:15360
    v_exp_f32 v91, v91
    v_exp_f32 v92, v92
    v_exp_f32 v93, v93
    v_exp_f32 v94, v94
    v_exp_f32 v95, v95
    v_cvt_pk_bf16_f32 v116, v88, v89
    v_cvt_pk_bf16_f32 v117, v90, v91
    v_cvt_pk_bf16_f32 v118, v92, v93
    v_cvt_pk_bf16_f32 v119, v94, v95
    v_exp_f32 v96, v96
    v_exp_f32 v97, v97
    v_mfma_f32_32x32x16_bf16 v[144:159], a[236:239], v[116:119], v[144:159]
    s_mov_b64 exec, s[96:97]
    buffer_load_dwordx4 a[176:179], v35, s[48:51], s65 offen offset:1024 sc1
    buffer_load_dwordx4 a[180:183], v35, s[48:51], s65 offen offset:1536 sc1
    s_mov_b64 exec, -1
    v_exp_f32 v98, v98
    v_exp_f32 v99, v99
    v_exp_f32 v100, v100
    v_exp_f32 v101, v101
    s_waitcnt vmcnt(14)
    v_mfma_f32_32x32x16_bf16 v[80:95], v[200:203], a[248:251], 0
    s_mov_b32 s50, s73
    s_add_u32 s65, s66, 65536
    buffer_load_dwordx4 v[180:183], v2, s[48:51], s65 offen sc1
    v_exp_f32 v102, v102
    v_exp_f32 v103, v103
    v_exp_f32 v104, v104
    v_cvt_pk_bf16_f32 v120, v96, v97
    v_cvt_pk_bf16_f32 v121, v98, v99
    v_cvt_pk_bf16_f32 v122, v100, v101
    v_cvt_pk_bf16_f32 v123, v102, v103
    v_exp_f32 v105, v105
    v_exp_f32 v106, v106
    v_mfma_f32_32x32x16_bf16 v[128:143], a[216:219], v[120:123], v[128:143]
    s_mov_b64 exec, s[96:97]
    buffer_load_dwordx4 a[168:171], v35, s[48:51], s65 offen offset:1024 sc1
    buffer_load_dwordx4 a[172:175], v35, s[48:51], s65 offen offset:1536 sc1
    s_mov_b64 exec, -1
    v_exp_f32 v107, v107
    v_exp_f32 v108, v108
    v_exp_f32 v109, v109
    v_exp_f32 v110, v110
    v_exp_f32 v111, v111
    v_cvt_pk_bf16_f32 v124, v104, v105
    v_cvt_pk_bf16_f32 v125, v106, v107
    v_cvt_pk_bf16_f32 v126, v108, v109
    v_cvt_pk_bf16_f32 v127, v110, v111
    v_exp_f32 v80, v80
    v_exp_f32 v81, v81
    v_mfma_f32_32x32x16_bf16 v[128:143], a[220:223], v[124:127], v[128:143]
    s_add_u32 s65, s66, 0
    buffer_load_dwordx4 v[176:179], v2, s[48:51], s65 offen sc1
    v_exp_f32 v82, v82
    v_exp_f32 v83, v83
    v_exp_f32 v84, v84
    v_exp_f32 v85, v85
    s_waitcnt vmcnt(15)
    v_mfma_f32_32x32x16_bf16 v[96:111], v[196:199], a[248:251], 0
    s_mov_b64 exec, s[96:97]
    buffer_load_dwordx4 a[160:163], v35, s[48:51], s65 offen offset:1024 sc1
    buffer_load_dwordx4 a[164:167], v35, s[48:51], s65 offen offset:1536 sc1
    s_mov_b64 exec, -1
    v_exp_f32 v86, v86
    v_exp_f32 v87, v87
    v_exp_f32 v88, v88
    v_cvt_pk_bf16_f32 v112, v80, v81
    v_cvt_pk_bf16_f32 v113, v82, v83
    v_cvt_pk_bf16_f32 v114, v84, v85
    v_cvt_pk_bf16_f32 v115, v86, v87
    v_exp_f32 v89, v89
    v_exp_f32 v90, v90
    v_mfma_f32_32x32x16_bf16 v[128:143], a[208:211], v[112:115], v[128:143]
    buffer_load_dword v3, v40, s[32:35], 0 offen sc1
    v_exp_f32 v91, v91
    v_exp_f32 v92, v92
    v_exp_f32 v93, v93
    v_exp_f32 v94, v94
    v_exp_f32 v95, v95
    v_cvt_pk_bf16_f32 v116, v88, v89
    v_cvt_pk_bf16_f32 v117, v90, v91
    v_cvt_pk_bf16_f32 v118, v92, v93
    v_cvt_pk_bf16_f32 v119, v94, v95
    v_exp_f32 v96, v96
    v_exp_f32 v97, v97
    v_mfma_f32_32x32x16_bf16 v[128:143], a[212:215], v[116:119], v[128:143]
    buffer_load_dword v78, v78, s[32:35], s56 offen
    v_exp_f32 v98, v98
    v_exp_f32 v99, v99
    v_exp_f32 v100, v100
    v_exp_f32 v101, v101
    s_waitcnt vmcnt(16)
    v_mfma_f32_32x32x16_bf16 v[80:95], v[192:195], a[248:251], 0
    s_add_u32 m0, s95, 36864
    s_mov_b32 s67, 528384
    buffer_load_dwordx4 v23, s[20:23], s67 offen offset:0 lds
    v_exp_f32 v102, v102
    v_exp_f32 v103, v103
    v_exp_f32 v104, v104
    v_cvt_pk_bf16_f32 v120, v96, v97
    v_cvt_pk_bf16_f32 v121, v98, v99
    v_cvt_pk_bf16_f32 v122, v100, v101
    v_cvt_pk_bf16_f32 v123, v102, v103
    v_exp_f32 v105, v105
    v_exp_f32 v106, v106
    v_mfma_f32_32x32x16_bf16 v[128:143], a[200:203], v[120:123], v[128:143]
    buffer_load_dwordx4 v24, s[20:23], s67 offen offset:1024 lds
    v_exp_f32 v107, v107
    v_exp_f32 v108, v108
    v_exp_f32 v109, v109
    v_exp_f32 v110, v110
    v_exp_f32 v111, v111
    v_cvt_pk_bf16_f32 v124, v104, v105
    v_cvt_pk_bf16_f32 v125, v106, v107
    v_cvt_pk_bf16_f32 v126, v108, v109
    v_cvt_pk_bf16_f32 v127, v110, v111
    v_exp_f32 v80, v80
    v_exp_f32 v81, v81
    v_mfma_f32_32x32x16_bf16 v[128:143], a[204:207], v[124:127], v[128:143]
    buffer_load_dwordx4 v25, s[20:23], s67 offen offset:2048 lds
    v_exp_f32 v82, v82
    v_exp_f32 v83, v83
    v_exp_f32 v84, v84
    v_exp_f32 v85, v85
    s_waitcnt vmcnt(16)
    v_mfma_f32_32x32x16_bf16 v[96:111], v[188:191], a[248:251], 0
    s_add_u32 m0, s95, 49152
    s_mov_b32 s67, 704512
    buffer_load_dwordx4 v23, s[20:23], s67 offen offset:0 lds
    v_exp_f32 v86, v86
    v_exp_f32 v87, v87
    v_exp_f32 v88, v88
    v_cvt_pk_bf16_f32 v112, v80, v81
    v_cvt_pk_bf16_f32 v113, v82, v83
    v_cvt_pk_bf16_f32 v114, v84, v85
    v_cvt_pk_bf16_f32 v115, v86, v87
    v_exp_f32 v89, v89
    v_exp_f32 v90, v90
    v_mfma_f32_32x32x16_bf16 v[128:143], a[192:195], v[112:115], v[128:143]
    buffer_load_dwordx4 v24, s[20:23], s67 offen offset:1024 lds
    v_exp_f32 v91, v91
    v_exp_f32 v92, v92
    v_exp_f32 v93, v93
    v_exp_f32 v94, v94
    v_exp_f32 v95, v95
    v_cvt_pk_bf16_f32 v116, v88, v89
    v_cvt_pk_bf16_f32 v117, v90, v91
    v_cvt_pk_bf16_f32 v118, v92, v93
    v_cvt_pk_bf16_f32 v119, v94, v95
    v_exp_f32 v96, v96
    v_exp_f32 v97, v97
    v_mfma_f32_32x32x16_bf16 v[128:143], a[196:199], v[116:119], v[128:143]
    v_exp_f32 v98, v98
    v_exp_f32 v99, v99
    v_exp_f32 v100, v100
    v_exp_f32 v101, v101
    s_waitcnt vmcnt(15)
    v_mfma_f32_32x32x16_bf16 v[80:95], v[184:187], a[248:251], 0
    buffer_load_dwordx4 v25, s[20:23], s67 offen offset:2048 lds
    v_exp_f32 v102, v102
    v_exp_f32 v103, v103
    v_exp_f32 v104, v104
    v_cvt_pk_bf16_f32 v120, v96, v97
    v_cvt_pk_bf16_f32 v121, v98, v99
    v_cvt_pk_bf16_f32 v122, v100, v101
    v_cvt_pk_bf16_f32 v123, v102, v103
    v_exp_f32 v105, v105
    v_exp_f32 v106, v106
    v_mfma_f32_32x32x16_bf16 v[128:143], a[184:187], v[120:123], v[128:143]
    s_add_u32 m0, s95, 61440
    s_mov_b32 s67, 880640
    buffer_load_dwordx4 v23, s[20:23], s67 offen offset:0 lds
    v_exp_f32 v107, v107
    v_exp_f32 v108, v108
    v_exp_f32 v109, v109
    v_exp_f32 v110, v110
    v_exp_f32 v111, v111
    v_cvt_pk_bf16_f32 v124, v104, v105
    v_cvt_pk_bf16_f32 v125, v106, v107
    v_cvt_pk_bf16_f32 v126, v108, v109
    v_cvt_pk_bf16_f32 v127, v110, v111
    v_exp_f32 v80, v80
    v_exp_f32 v81, v81
    v_mfma_f32_32x32x16_bf16 v[128:143], a[188:191], v[124:127], v[128:143]
    buffer_load_dwordx4 v24, s[20:23], s67 offen offset:1024 lds
    v_exp_f32 v82, v82
    v_exp_f32 v83, v83
    v_exp_f32 v84, v84
    v_exp_f32 v85, v85
    s_waitcnt vmcnt(15)
    v_mfma_f32_32x32x16_bf16 v[96:111], v[180:183], a[248:251], 0
    buffer_load_dwordx4 v25, s[20:23], s67 offen offset:2048 lds
    v_exp_f32 v86, v86
    v_exp_f32 v87, v87
    v_exp_f32 v88, v88
    v_cvt_pk_bf16_f32 v112, v80, v81
    v_cvt_pk_bf16_f32 v113, v82, v83
    v_cvt_pk_bf16_f32 v114, v84, v85
    v_cvt_pk_bf16_f32 v115, v86, v87
    v_exp_f32 v89, v89
    v_exp_f32 v90, v90
    v_mfma_f32_32x32x16_bf16 v[128:143], a[176:179], v[112:115], v[128:143]
    v_exp_f32 v91, v91
    v_exp_f32 v92, v92
    v_exp_f32 v93, v93
    v_exp_f32 v94, v94
    v_exp_f32 v95, v95
    v_cvt_pk_bf16_f32 v116, v88, v89
    v_cvt_pk_bf16_f32 v117, v90, v91
    v_cvt_pk_bf16_f32 v118, v92, v93
    v_cvt_pk_bf16_f32 v119, v94, v95
    v_exp_f32 v96, v96
    v_exp_f32 v97, v97
    v_mfma_f32_32x32x16_bf16 v[128:143], a[180:183], v[116:119], v[128:143]
    s_mul_i32 s65, s3, 11
    v_add_lshl_u32 v79, v1, s65, 10
    s_mov_b64 exec, 2047
    buffer_load_dword v79, v79, s[24:27], 0 offen offset:384
    s_mov_b64 exec, -1
    v_exp_f32 v98, v98
    v_exp_f32 v99, v99
    v_exp_f32 v100, v100
    v_exp_f32 v101, v101
    s_waitcnt vmcnt(14)
    v_mfma_f32_32x32x16_bf16 v[80:95], v[176:179], a[248:251], v[224:239]
    s_add_u32 m0, s95, 73728
    s_mov_b32 s67, 1056768
    buffer_load_dwordx4 v23, s[20:23], s67 offen offset:0 lds
    v_exp_f32 v102, v102
    v_exp_f32 v103, v103
    v_exp_f32 v104, v104
    v_cvt_pk_bf16_f32 v120, v96, v97
    v_cvt_pk_bf16_f32 v121, v98, v99
    v_cvt_pk_bf16_f32 v122, v100, v101
    v_cvt_pk_bf16_f32 v123, v102, v103
    v_exp_f32 v105, v105
    v_exp_f32 v106, v106
    v_mfma_f32_32x32x16_bf16 v[128:143], a[168:171], v[120:123], v[128:143]
    buffer_load_dwordx4 v24, s[20:23], s67 offen offset:1024 lds
    v_exp_f32 v107, v107
    v_exp_f32 v108, v108
    v_exp_f32 v109, v109
    v_exp_f32 v110, v110
    v_exp_f32 v111, v111
    v_cvt_pk_bf16_f32 v124, v104, v105
    v_cvt_pk_bf16_f32 v125, v106, v107
    v_cvt_pk_bf16_f32 v126, v108, v109
    v_cvt_pk_bf16_f32 v127, v110, v111
    v_exp_f32 v80, v80
    v_exp_f32 v81, v81
    v_mfma_f32_32x32x16_bf16 v[128:143], a[172:175], v[124:127], v[128:143]
    buffer_load_dwordx4 v25, s[20:23], s67 offen offset:2048 lds
    v_exp_f32 v82, v82
    v_exp_f32 v83, v83
    v_exp_f32 v84, v84
    v_exp_f32 v85, v85
    v_mfma_f32_32x32x16_bf16 v[96:111], v[204:207], a[252:255], 0
    v_exp_f32 v86, v86
    v_exp_f32 v87, v87
    v_exp_f32 v88, v88
    v_cvt_pk_bf16_f32 v112, v80, v81
    v_cvt_pk_bf16_f32 v113, v82, v83
    v_cvt_pk_bf16_f32 v114, v84, v85
    v_cvt_pk_bf16_f32 v115, v86, v87
    v_exp_f32 v89, v89
    v_exp_f32 v90, v90
    s_waitcnt vmcnt(16)
    v_mfma_f32_32x32x16_bf16 v[128:143], a[160:163], v[112:115], v[128:143]
    s_add_u32 m0, s95, 86016
    s_mov_b32 s67, 1232896
    buffer_load_dwordx4 v23, s[20:23], s67 offen offset:0 lds
    v_exp_f32 v91, v91
    v_exp_f32 v92, v92
    v_exp_f32 v93, v93
    v_exp_f32 v94, v94
    v_exp_f32 v95, v95
    v_cvt_pk_bf16_f32 v116, v88, v89
    v_cvt_pk_bf16_f32 v117, v90, v91
    v_cvt_pk_bf16_f32 v118, v92, v93
    v_cvt_pk_bf16_f32 v119, v94, v95
    v_exp_f32 v96, v96
    v_exp_f32 v97, v97
    s_waitcnt vmcnt(16)
    v_mfma_f32_32x32x16_bf16 v[128:143], a[164:167], v[116:119], v[128:143]
    buffer_load_dwordx4 v24, s[20:23], s67 offen offset:1024 lds
    v_exp_f32 v98, v98
    v_exp_f32 v99, v99
    v_exp_f32 v100, v100
    v_exp_f32 v101, v101
    v_mfma_f32_32x32x16_bf16 v[80:95], v[200:203], a[252:255], 0
    buffer_load_dwordx4 v25, s[20:23], s67 offen offset:2048 lds
    v_exp_f32 v102, v102
    v_exp_f32 v103, v103
    v_exp_f32 v104, v104
    v_cvt_pk_bf16_f32 v120, v96, v97
    v_cvt_pk_bf16_f32 v121, v98, v99
    v_cvt_pk_bf16_f32 v122, v100, v101
    v_cvt_pk_bf16_f32 v123, v102, v103
    v_exp_f32 v105, v105
    v_exp_f32 v106, v106
    v_mfma_f32_32x32x16_bf16 v[144:159], a[216:219], v[120:123], v[144:159]
    v_med3_f32 v77, v136, s78, v22
    v_cmp_neq_f32 s[0:1], v77, v136
    v_rcp_f32 v136, v136
    s_nop 0
    v_mul_f32 v128, v128, v136
    v_mul_f32 v129, v129, v136
    v_mul_f32 v130, v130, v136
    v_mul_f32 v131, v131, v136
    v_mul_f32 v132, v132, v136
    v_mul_f32 v133, v133, v136
    v_mul_f32 v134, v134, v136
    v_mul_f32 v135, v135, v136
    v_cvt_pk_bf16_f32 v72, v128, v129
    v_cvt_pk_bf16_f32 v73, v130, v131
    v_cvt_pk_bf16_f32 v74, v132, v133
    v_cvt_pk_bf16_f32 v75, v134, v135
    s_add_u32 m0, s95, 0
    s_mov_b32 s67, 0
    buffer_load_dwordx4 v23, s[20:23], s67 offen offset:0 lds
    v_exp_f32 v107, v107
    v_exp_f32 v108, v108
    v_exp_f32 v109, v109
    v_exp_f32 v110, v110
    v_exp_f32 v111, v111
    v_cvt_pk_bf16_f32 v124, v104, v105
    v_cvt_pk_bf16_f32 v125, v106, v107
    v_cvt_pk_bf16_f32 v126, v108, v109
    v_cvt_pk_bf16_f32 v127, v110, v111
    v_exp_f32 v80, v80
    v_exp_f32 v81, v81
    v_mfma_f32_32x32x16_bf16 v[144:159], a[220:223], v[124:127], v[144:159]
    v_exp_f32 v82, v82
    v_exp_f32 v83, v83
    v_exp_f32 v84, v84
    v_exp_f32 v85, v85
    v_mfma_f32_32x32x16_bf16 v[96:111], v[196:199], a[252:255], 0
    buffer_load_dwordx4 v24, s[20:23], s67 offen offset:1024 lds
    v_exp_f32 v86, v86
    v_exp_f32 v87, v87
    v_exp_f32 v88, v88
    v_cvt_pk_bf16_f32 v112, v80, v81
    v_cvt_pk_bf16_f32 v113, v82, v83
    v_cvt_pk_bf16_f32 v114, v84, v85
    v_cvt_pk_bf16_f32 v115, v86, v87
    v_exp_f32 v89, v89
    v_exp_f32 v90, v90
    v_mfma_f32_32x32x16_bf16 v[144:159], a[208:211], v[112:115], v[144:159]
    buffer_load_dwordx4 v25, s[20:23], s67 offen offset:2048 lds
    v_exp_f32 v91, v91
    v_exp_f32 v92, v92
    v_exp_f32 v93, v93
    v_exp_f32 v94, v94
    v_exp_f32 v95, v95
    v_cvt_pk_bf16_f32 v116, v88, v89
    v_cvt_pk_bf16_f32 v117, v90, v91
    v_cvt_pk_bf16_f32 v118, v92, v93
    v_cvt_pk_bf16_f32 v119, v94, v95
    v_exp_f32 v96, v96
    v_exp_f32 v97, v97
    v_mfma_f32_32x32x16_bf16 v[144:159], a[212:215], v[116:119], v[144:159]
    s_add_u32 m0, s95, 12288
    s_mov_b32 s67, 176128
    buffer_load_dwordx4 v23, s[20:23], s67 offen offset:0 lds
    v_exp_f32 v98, v98
    v_exp_f32 v99, v99
    v_exp_f32 v100, v100
    v_exp_f32 v101, v101
    v_mfma_f32_32x32x16_bf16 v[80:95], v[192:195], a[252:255], 0
    buffer_load_dwordx4 v24, s[20:23], s67 offen offset:1024 lds
    v_exp_f32 v102, v102
    v_exp_f32 v103, v103
    v_exp_f32 v104, v104
    v_cvt_pk_bf16_f32 v120, v96, v97
    v_cvt_pk_bf16_f32 v121, v98, v99
    v_cvt_pk_bf16_f32 v122, v100, v101
    v_cvt_pk_bf16_f32 v123, v102, v103
    v_exp_f32 v105, v105
    v_exp_f32 v106, v106
    v_mfma_f32_32x32x16_bf16 v[144:159], a[200:203], v[120:123], v[144:159]
    v_exp_f32 v107, v107
    v_exp_f32 v108, v108
    v_exp_f32 v109, v109
    v_exp_f32 v110, v110
    v_exp_f32 v111, v111
    v_cvt_pk_bf16_f32 v124, v104, v105
    v_cvt_pk_bf16_f32 v125, v106, v107
    v_cvt_pk_bf16_f32 v126, v108, v109
    v_cvt_pk_bf16_f32 v127, v110, v111
    v_exp_f32 v80, v80
    v_exp_f32 v81, v81
    v_mfma_f32_32x32x16_bf16 v[144:159], a[204:207], v[124:127], v[144:159]
    buffer_load_dwordx4 v25, s[20:23], s67 offen offset:2048 lds
    v_exp_f32 v82, v82
    v_exp_f32 v83, v83
    v_exp_f32 v84, v84
    v_exp_f32 v85, v85
    v_mfma_f32_32x32x16_bf16 v[96:111], v[188:191], a[252:255], 0
    s_add_u32 m0, s95, 24576
    s_mov_b32 s67, 352256
    buffer_load_dwordx4 v23, s[20:23], s67 offen offset:0 lds
    v_exp_f32 v86, v86
    v_exp_f32 v87, v87
    v_exp_f32 v88, v88
    v_cvt_pk_bf16_f32 v112, v80, v81
    v_cvt_pk_bf16_f32 v113, v82, v83
    v_cvt_pk_bf16_f32 v114, v84, v85
    v_cvt_pk_bf16_f32 v115, v86, v87
    v_exp_f32 v89, v89
    v_exp_f32 v90, v90
    v_mfma_f32_32x32x16_bf16 v[144:159], a[192:195], v[112:115], v[144:159]
    buffer_load_dwordx4 v24, s[20:23], s67 offen offset:1024 lds
    v_exp_f32 v91, v91
    v_exp_f32 v92, v92
    v_exp_f32 v93, v93
    v_exp_f32 v94, v94
    v_exp_f32 v95, v95
    v_cvt_pk_bf16_f32 v116, v88, v89
    v_cvt_pk_bf16_f32 v117, v90, v91
    v_cvt_pk_bf16_f32 v118, v92, v93
    v_cvt_pk_bf16_f32 v119, v94, v95
    v_exp_f32 v96, v96
    v_exp_f32 v97, v97
    v_mfma_f32_32x32x16_bf16 v[144:159], a[196:199], v[116:119], v[144:159]
    buffer_load_dwordx4 v25, s[20:23], s67 offen offset:2048 lds
    v_exp_f32 v98, v98
    v_exp_f32 v99, v99
    v_exp_f32 v100, v100
    v_exp_f32 v101, v101
    v_mfma_f32_32x32x16_bf16 v[80:95], v[184:187], a[252:255], 0
    v_exp_f32 v102, v102
    v_exp_f32 v103, v103
    v_exp_f32 v104, v104
    v_cvt_pk_bf16_f32 v120, v96, v97
    v_cvt_pk_bf16_f32 v121, v98, v99
    v_cvt_pk_bf16_f32 v122, v100, v101
    v_cvt_pk_bf16_f32 v123, v102, v103
    v_exp_f32 v105, v105
    v_exp_f32 v106, v106
    v_mfma_f32_32x32x16_bf16 v[144:159], a[184:187], v[120:123], v[144:159]
    v_exp_f32 v107, v107
    v_exp_f32 v108, v108
    v_exp_f32 v109, v109
    v_exp_f32 v110, v110
    v_exp_f32 v111, v111
    v_cvt_pk_bf16_f32 v124, v104, v105
    v_cvt_pk_bf16_f32 v125, v106, v107
    v_cvt_pk_bf16_f32 v126, v108, v109
    v_cvt_pk_bf16_f32 v127, v110, v111
    v_exp_f32 v80, v80
    v_exp_f32 v81, v81
    v_mfma_f32_32x32x16_bf16 v[144:159], a[188:191], v[124:127], v[144:159]
    buffer_store_dwordx4 v[72:75], v2, s[32:35], s92 offen sc1
    v_exp_f32 v82, v82
    v_exp_f32 v83, v83
    v_exp_f32 v84, v84
    v_exp_f32 v85, v85
    v_mfma_f32_32x32x16_bf16 v[96:111], v[180:183], a[252:255], v[224:239]
    v_exp_f32 v86, v86
    v_exp_f32 v87, v87
    v_exp_f32 v88, v88
    v_cvt_pk_bf16_f32 v112, v80, v81
    v_cvt_pk_bf16_f32 v113, v82, v83
    v_cvt_pk_bf16_f32 v114, v84, v85
    v_cvt_pk_bf16_f32 v115, v86, v87
    v_exp_f32 v89, v89
    v_exp_f32 v90, v90
    v_mfma_f32_32x32x16_bf16 v[144:159], a[176:179], v[112:115], v[144:159]
    v_exp_f32 v91, v91
    v_exp_f32 v92, v92
    v_exp_f32 v93, v93
    v_exp_f32 v94, v94
    v_exp_f32 v95, v95
    v_cvt_pk_bf16_f32 v116, v88, v89
    v_cvt_pk_bf16_f32 v117, v90, v91
    v_cvt_pk_bf16_f32 v118, v92, v93
    v_cvt_pk_bf16_f32 v119, v94, v95
    v_exp_f32 v96, v96
    v_exp_f32 v97, v97
    v_mfma_f32_32x32x16_bf16 v[144:159], a[180:183], v[116:119], v[144:159]
    v_exp_f32 v98, v98
    v_exp_f32 v99, v99
    v_exp_f32 v100, v100
    v_exp_f32 v101, v101
    v_exp_f32 v102, v102
    v_exp_f32 v103, v103
    v_exp_f32 v104, v104
    v_cvt_pk_bf16_f32 v120, v96, v97
    v_cvt_pk_bf16_f32 v121, v98, v99
    v_cvt_pk_bf16_f32 v122, v100, v101
    v_cvt_pk_bf16_f32 v123, v102, v103
    v_exp_f32 v105, v105
    v_exp_f32 v106, v106
    v_mfma_f32_32x32x16_bf16 v[144:159], a[168:171], v[120:123], v[144:159]
    v_exp_f32 v107, v107
    v_exp_f32 v108, v108
    v_exp_f32 v109, v109
    v_exp_f32 v110, v110
    v_exp_f32 v111, v111
    v_cvt_pk_bf16_f32 v124, v104, v105
    v_cvt_pk_bf16_f32 v125, v106, v107
    v_cvt_pk_bf16_f32 v126, v108, v109
    v_cvt_pk_bf16_f32 v127, v110, v111
    s_nop 1
    v_mfma_f32_32x32x16_bf16 v[144:159], a[172:175], v[124:127], v[144:159]
    s_waitcnt vmcnt(27)
    v_cmp_gt_u32 vcc, 1, v3
    s_cbranch_vccnz L_ap3_s
L_ap3_r:
    v_readfirstlane_b32 s64, v3
    s_lshl_b32 s65, s81, 6
    v_add_u32 v46, s65, v31
    v_add_u32 v47, s65, v34
    v_cmp_ne_u32 vcc, s64, v3
    v_mov_b32 v18, 0
    v_mov_b32 v19, 0
    s_and_b32 s80, vcc_lo, 0xffff
    s_nop 0
    v_med3_f32 v77, v152, s78, v22
    v_cmp_neq_f32 vcc, v77, v152
    v_rcp_f32 v152, v152
    s_nop 0
    v_pk_mul_f32 v[144:145], v[144:145], v[152:153] op_sel_hi:[1,0]
    v_pk_mul_f32 v[146:147], v[146:147], v[152:153] op_sel_hi:[1,0]
    v_pk_mul_f32 v[148:149], v[148:149], v[152:153] op_sel_hi:[1,0]
    v_pk_mul_f32 v[150:151], v[150:151], v[152:153] op_sel_hi:[1,0]
    v_cvt_pk_bf16_f32 v64, v144, v145
    v_cvt_pk_bf16_f32 v65, v146, v147
    v_cvt_pk_bf16_f32 v66, v148, v149
    v_cvt_pk_bf16_f32 v67, v150, v151
    buffer_store_dwordx4 v[64:67], v2, s[32:35], s93 offen sc1
    s_or_b64 vcc, vcc, s[0:1]
    s_cbranch_vccnz L_fallback
L_fbret:
    s_waitcnt vmcnt(2)
    s_waitcnt lgkmcnt(0)
    s_barrier
    s_add_u32 m0, s77, 98304
    s_add_u32 s67, s87, 0
    buffer_load_dwordx4 v12, s[24:27], s67 offen offset:0 lds
    buffer_load_dwordx4 v13, s[24:27], s67 offen offset:1024 lds
    buffer_load_dwordx4 v14, s[24:27], s67 offen offset:2048 lds
    ds_read_b64_tr_b16 a[64:65], v32 offset:32768
    ds_read_b64_tr_b16 a[66:67], v32 offset:33792
    ds_read_b64_tr_b16 a[68:69], v33 offset:32768
    ds_read_b64_tr_b16 a[70:71], v33 offset:33792
    ds_read_b64_tr_b16 a[72:73], v32 offset:34816
    ds_read_b64_tr_b16 a[74:75], v32 offset:35840
    ds_read_b64_tr_b16 a[76:77], v33 offset:34816
    ds_read_b64_tr_b16 a[78:79], v33 offset:35840
    ds_read_b64_tr_b16 a[80:81], v32 offset:36864
    ds_read_b64_tr_b16 a[82:83], v32 offset:37888
    ds_read_b64_tr_b16 a[84:85], v33 offset:36864
    ds_read_b64_tr_b16 a[86:87], v33 offset:37888
    ds_read_b64_tr_b16 a[88:89], v32 offset:38912
    ds_read_b64_tr_b16 a[90:91], v32 offset:39936
    ds_read_b64_tr_b16 a[92:93], v33 offset:38912
    ds_read_b64_tr_b16 a[94:95], v33 offset:39936
    ds_read_b64_tr_b16 a[96:97], v32 offset:40960
    ds_read_b64_tr_b16 a[98:99], v32 offset:41984
    ds_read_b64_tr_b16 a[100:101], v33 offset:40960
    ds_read_b64_tr_b16 a[102:103], v33 offset:41984
    ds_read_b64_tr_b16 a[104:105], v32 offset:43008
    ds_read_b64_tr_b16 a[106:107], v32 offset:44032
    ds_read_b64_tr_b16 a[108:109], v33 offset:43008
    ds_read_b64_tr_b16 a[110:111], v33 offset:44032
    ds_read_b64_tr_b16 a[112:113], v32 offset:45056
    ds_read_b64_tr_b16 a[114:115], v32 offset:46080
    ds_read_b64_tr_b16 a[116:117], v33 offset:45056
    ds_read_b64_tr_b16 a[118:119], v33 offset:46080
    ds_read_b64_tr_b16 a[120:121], v32 offset:47104
    ds_read_b64_tr_b16 a[122:123], v32 offset:48128
    ds_read_b64_tr_b16 a[124:125], v33 offset:47104
    ds_read_b64_tr_b16 a[126:127], v33 offset:48128
    buffer_load_dwordx4 v15, s[24:27], s67 offen offset:3072 lds
    s_add_u32 m0, s77, 114688
    s_add_u32 s67, s87, 393216
    buffer_load_dwordx4 v12, s[24:27], s67 offen offset:0 lds
    buffer_load_dwordx4 v13, s[24:27], s67 offen offset:1024 lds
    buffer_load_dwordx4 v14, s[24:27], s67 offen offset:2048 lds
    buffer_load_dwordx4 v15, s[24:27], s67 offen offset:3072 lds
    s_lshl_b32 s64, s59, 11
    v_add_u32 v26, s64, v30
    v_xor_b32 v27, 64, v26
    v_add_u32 v32, 98304, v26
    v_add_u32 v33, 98304, v27
    s_waitcnt vmcnt(8)
    s_cmp_lg_u32 s80, 0
    s_mov_b64 exec, 1
    s_cbranch_scc1 L_fl4
    buffer_store_dword v4, v5, s[32:35], s69 offen
L_fl4_r:
    s_mov_b64 exec, -1
    v_lshlrev_b32 v240, 16, v160
    v_and_b32 v241, s61, v160
    v_lshlrev_b32 v242, 16, v161
    v_and_b32 v243, s61, v161
    v_lshlrev_b32 v244, 16, v162
    v_and_b32 v245, s61, v162
    v_lshlrev_b32 v246, 16, v163
    v_and_b32 v247, s61, v163
    v_lshlrev_b32 v248, 16, v164
    v_and_b32 v249, s61, v164
    v_lshlrev_b32 v250, 16, v165
    v_and_b32 v251, s61, v165
    v_lshlrev_b32 v252, 16, v166
    v_and_b32 v253, s61, v166
    v_lshlrev_b32 v254, 16, v167
    v_and_b32 v255, s61, v167
    buffer_load_dword v3, v29, s[32:35], s84 offen sc1
    ds_read_b64_tr_b16 v[176:177], v46 offset:0
    ds_read_b64_tr_b16 v[178:179], v46 offset:1536
    ds_read_b64_tr_b16 v[180:181], v46 offset:3072
    ds_read_b64_tr_b16 v[182:183], v46 offset:4608
    ds_read_b64_tr_b16 v[184:185], v46 offset:6144
    ds_read_b64_tr_b16 v[186:187], v46 offset:7680
    ds_read_b64_tr_b16 v[188:189], v46 offset:9216
    ds_read_b64_tr_b16 v[190:191], v46 offset:10752
    ds_read_b64_tr_b16 v[192:193], v46 offset:12288
    ds_read_b64_tr_b16 v[194:195], v46 offset:13824
    ds_read_b64_tr_b16 v[196:197], v46 offset:15360
    ds_read_b64_tr_b16 v[198:199], v46 offset:16896
    ds_read_b64_tr_b16 v[200:201], v46 offset:18432
    ds_read_b64_tr_b16 v[202:203], v46 offset:19968
    ds_read_b64_tr_b16 v[204:205], v46 offset:21504
    ds_read_b64_tr_b16 v[206:207], v46 offset:23040
    ds_read_b64_tr_b16 v[208:209], v46 offset:24576
    ds_read_b64_tr_b16 v[210:211], v46 offset:26112
    ds_read_b64_tr_b16 v[212:213], v46 offset:27648
    ds_read_b64_tr_b16 v[214:215], v46 offset:29184
    ds_read_b64_tr_b16 v[216:217], v46 offset:30720
    ds_read_b64_tr_b16 v[218:219], v46 offset:32256
    ds_read_b64_tr_b16 v[220:221], v46 offset:33792
    ds_read_b64_tr_b16 v[222:223], v46 offset:35328
    ds_read_b64_tr_b16 v[224:225], v46 offset:36864
    ds_read_b64_tr_b16 v[226:227], v46 offset:38400
    ds_read_b64_tr_b16 v[228:229], v46 offset:39936
    ds_read_b64_tr_b16 v[230:231], v46 offset:41472
    ds_read_b64_tr_b16 v[232:233], v46 offset:43008
    ds_read_b64_tr_b16 v[234:235], v46 offset:44544
    ds_read_b64_tr_b16 v[236:237], v46 offset:46080
    ds_read_b64_tr_b16 v[238:239], v46 offset:47616
    s_mov_b32 s72, 0
L_bp5:
    s_waitcnt vmcnt(0)
    v_cmp_gt_u32 vcc, 1, v3
    s_add_u32 s72, s72, 1
    s_bitcmp1_b32 s72, 20
    buffer_load_dword v3, v29, s[32:35], s84 offen sc1
    s_cbranch_scc1 L_bp5_x
    s_cbranch_vccnz L_bp5
L_bp5_x:
    buffer_load_dwordx4 v[64:67], v2, s[32:35], s90 offen offset:0 sc1
    buffer_load_dwordx4 v[68:71], v2, s[32:35], s90 offen offset:1024 sc1
    buffer_load_dwordx4 v[72:75], v2, s[32:35], s90 offen offset:2048 sc1
    buffer_load_dwordx4 v[76:79], v2, s[32:35], s90 offen offset:3072 sc1
    s_add_u32 s90, s90, 4096
    buffer_load_dwordx4 v[80:83], v2, s[32:35], s90 offen offset:0 sc1
    s_waitcnt lgkmcnt(14)
    v_dot2c_f32_bf16 v18, s60, v176
    v_dot2c_f32_bf16 v19, s60, v177
    v_dot2c_f32_bf16 v18, s60, v178
    v_dot2c_f32_bf16 v19, s60, v179
    v_dot2c_f32_bf16 v18, s60, v180
    v_dot2c_f32_bf16 v19, s60, v181
    v_dot2c_f32_bf16 v18, s60, v182
    v_dot2c_f32_bf16 v19, s60, v183
    v_dot2c_f32_bf16 v18, s60, v184
    v_dot2c_f32_bf16 v19, s60, v185
    v_dot2c_f32_bf16 v18, s60, v186
    v_dot2c_f32_bf16 v19, s60, v187
    v_dot2c_f32_bf16 v18, s60, v188
    v_dot2c_f32_bf16 v19, s60, v189
    v_dot2c_f32_bf16 v18, s60, v190
    v_dot2c_f32_bf16 v19, s60, v191
    buffer_load_dwordx4 v[84:87], v2, s[32:35], s90 offen offset:1024 sc1
    v_dot2c_f32_bf16 v18, s60, v192
    v_dot2c_f32_bf16 v19, s60, v193
    v_dot2c_f32_bf16 v18, s60, v194
    v_dot2c_f32_bf16 v19, s60, v195
    v_dot2c_f32_bf16 v18, s60, v196
    v_dot2c_f32_bf16 v19, s60, v197
    v_dot2c_f32_bf16 v18, s60, v198
    v_dot2c_f32_bf16 v19, s60, v199
    v_dot2c_f32_bf16 v18, s60, v200
    v_dot2c_f32_bf16 v19, s60, v201
    v_dot2c_f32_bf16 v18, s60, v202
    v_dot2c_f32_bf16 v19, s60, v203
    v_dot2c_f32_bf16 v18, s60, v204
    v_dot2c_f32_bf16 v19, s60, v205
    v_dot2c_f32_bf16 v18, s60, v206
    v_dot2c_f32_bf16 v19, s60, v207
    buffer_load_dwordx4 v[88:91], v2, s[32:35], s90 offen offset:2048 sc1
    v_dot2c_f32_bf16 v18, s60, v208
    v_dot2c_f32_bf16 v19, s60, v209
    v_dot2c_f32_bf16 v18, s60, v210
    v_dot2c_f32_bf16 v19, s60, v211
    s_waitcnt lgkmcnt(13)
    v_dot2c_f32_bf16 v18, s60, v212
    v_dot2c_f32_bf16 v19, s60, v213
    s_waitcnt lgkmcnt(12)
    v_dot2c_f32_bf16 v18, s60, v214
    v_dot2c_f32_bf16 v19, s60, v215
    s_waitcnt lgkmcnt(11)
    v_dot2c_f32_bf16 v18, s60, v216
    v_dot2c_f32_bf16 v19, s60, v217
    s_waitcnt lgkmcnt(10)
    v_dot2c_f32_bf16 v18, s60, v218
    v_dot2c_f32_bf16 v19, s60, v219
    s_waitcnt lgkmcnt(9)
    v_dot2c_f32_bf16 v18, s60, v220
    v_dot2c_f32_bf16 v19, s60, v221
    s_waitcnt lgkmcnt(8)
    v_dot2c_f32_bf16 v18, s60, v222
    v_dot2c_f32_bf16 v19, s60, v223
    buffer_load_dwordx4 v[92:95], v2, s[32:35], s90 offen offset:3072 sc1
    s_waitcnt lgkmcnt(7)
    v_dot2c_f32_bf16 v18, s60, v224
    v_dot2c_f32_bf16 v19, s60, v225
    s_waitcnt lgkmcnt(6)
    v_dot2c_f32_bf16 v18, s60, v226
    v_dot2c_f32_bf16 v19, s60, v227
    s_waitcnt lgkmcnt(5)
    v_dot2c_f32_bf16 v18, s60, v228
    v_dot2c_f32_bf16 v19, s60, v229
    s_waitcnt lgkmcnt(4)
    v_dot2c_f32_bf16 v18, s60, v230
    v_dot2c_f32_bf16 v19, s60, v231
    s_waitcnt lgkmcnt(3)
    v_dot2c_f32_bf16 v18, s60, v232
    v_dot2c_f32_bf16 v19, s60, v233
    s_waitcnt lgkmcnt(2)
    v_dot2c_f32_bf16 v18, s60, v234
    v_dot2c_f32_bf16 v19, s60, v235
    s_waitcnt lgkmcnt(1)
    v_dot2c_f32_bf16 v18, s60, v236
    v_dot2c_f32_bf16 v19, s60, v237
    s_waitcnt lgkmcnt(0)
    v_dot2c_f32_bf16 v18, s60, v238
    v_dot2c_f32_bf16 v19, s60, v239
    s_add_u32 s90, s90, 4096
    buffer_load_dwordx4 v[96:99], v2, s[32:35], s90 offen offset:0 sc1
    s_waitcnt vmcnt(8)
    v_mfma_f32_32x32x16_bf16 v[144:159], a[4:7], v[64:67], 0
    buffer_load_dwordx4 v[100:103], v2, s[32:35], s90 offen offset:1024 sc1
    s_add_u32 s64, s77, 147456
    v_add_u32 v41, s64, v2
    v_mfma_f32_32x32x16_bf16 v[128:143], a[0:3], v[64:67], v[240:255]
    v_xor_b32 v42, 4096, v41
    s_and_b32 s70, s94, 63
    s_lshl2_add_u32 s70, s70, s56
    s_add_u32 s70, s70, 256
    s_lshl_b32 s7, s94, 8
    s_add_u32 s7, s7, 262144
    s_waitcnt vmcnt(8)
    v_mfma_f32_32x32x16_bf16 v[144:159], a[12:15], v[68:71], v[144:159]
    s_barrier
    buffer_load_dwordx4 v[104:107], v2, s[32:35], s90 offen offset:2048 sc1
    s_lshl_b32 s94, s94, 11
    s_add_u32 s94, s94, 7340032
    v_mfma_f32_32x32x16_bf16 v[128:143], a[8:11], v[68:71], v[128:143]
    ds_read_b64_tr_b16 a[132:133], v33 offset:0
    ds_read_b64_tr_b16 a[134:135], v33 offset:1024
    ds_read_b64_tr_b16 a[128:129], v32 offset:0
    ds_read_b64_tr_b16 a[130:131], v32 offset:1024
    s_waitcnt vmcnt(8)
    v_mfma_f32_32x32x16_bf16 v[144:159], a[20:23], v[72:75], v[144:159]
    buffer_load_dwordx4 v[108:111], v2, s[32:35], s90 offen offset:3072 sc1
    s_lshl_b32 s85, s52, 6
    s_add_u32 s85, s85, s56
    v_mfma_f32_32x32x16_bf16 v[128:143], a[16:19], v[72:75], v[128:143]
    ds_read_b64_tr_b16 a[140:141], v33 offset:4096
    ds_read_b64_tr_b16 a[142:143], v33 offset:5120
    ds_read_b64_tr_b16 a[136:137], v32 offset:4096
    ds_read_b64_tr_b16 a[138:139], v32 offset:5120
    s_waitcnt vmcnt(8)
    v_mfma_f32_32x32x16_bf16 v[144:159], a[28:31], v[76:79], v[144:159]
    s_add_u32 s90, s90, 4096
    buffer_load_dwordx4 v[112:115], v2, s[32:35], s90 offen offset:0 sc1
    s_add_u32 s85, s85, 256
    s_lshl2_add_u32 s71, s57, s85
    v_mfma_f32_32x32x16_bf16 v[128:143], a[24:27], v[76:79], v[128:143]
    ds_read_b64_tr_b16 a[148:149], v33 offset:8192
    ds_read_b64_tr_b16 a[150:151], v33 offset:9216
    ds_read_b64_tr_b16 a[144:145], v32 offset:8192
    ds_read_b64_tr_b16 a[146:147], v32 offset:9216
    s_waitcnt vmcnt(8)
    v_mfma_f32_32x32x16_bf16 v[144:159], a[36:39], v[80:83], v[144:159]
    buffer_load_dwordx4 v[116:119], v2, s[32:35], s90 offen offset:1024 sc1
    s_add_u32 s71, s71, 256
    s_and_b32 s86, s70, 0xffffffc0
    v_mfma_f32_32x32x16_bf16 v[128:143], a[32:35], v[80:83], v[128:143]
    ds_read_b64_tr_b16 a[156:157], v33 offset:12288
    ds_read_b64_tr_b16 a[158:159], v33 offset:13312
    ds_read_b64_tr_b16 a[152:153], v32 offset:12288
    ds_read_b64_tr_b16 a[154:155], v32 offset:13312
    s_waitcnt vmcnt(8)
    v_mfma_f32_32x32x16_bf16 v[144:159], a[44:47], v[84:87], v[144:159]
    buffer_load_dwordx4 v[120:123], v2, s[32:35], s90 offen offset:2048 sc1
    s_add_u32 s86, s86, 256
    s_lshr_b32 s89, s54, 1
    v_mfma_f32_32x32x16_bf16 v[128:143], a[40:43], v[84:87], v[128:143]
    ds_read_b64_tr_b16 a[164:165], v33 offset:16384
    ds_read_b64_tr_b16 a[166:167], v33 offset:17408
    ds_read_b64_tr_b16 a[160:161], v32 offset:16384
    ds_read_b64_tr_b16 a[162:163], v32 offset:17408
    s_waitcnt vmcnt(8)
    v_mfma_f32_32x32x16_bf16 v[144:159], a[52:55], v[88:91], v[144:159]
    buffer_load_dwordx4 v[124:127], v2, s[32:35], s90 offen offset:3072 sc1
    s_lshl2_add_u32 s89, s89, s52
    s_mul_i32 s6, s89, 88
    v_mfma_f32_32x32x16_bf16 v[128:143], a[48:51], v[88:91], v[128:143]
    ds_read_b64_tr_b16 a[172:173], v33 offset:20480
    ds_read_b64_tr_b16 a[174:175], v33 offset:21504
    ds_read_b64_tr_b16 a[168:169], v32 offset:20480
    ds_read_b64_tr_b16 a[170:171], v32 offset:21504
    s_waitcnt vmcnt(8)
    v_mfma_f32_32x32x16_bf16 v[144:159], a[60:63], v[92:95], v[144:159]
    s_add_u32 m0, s77, 131072
    s_add_u32 s67, s87, 786432
    buffer_load_dwordx4 v12, s[24:27], s67 offen offset:0 lds
    s_add_u32 s6, s6, s57
    s_lshl_b32 s6, s6, 10
    v_mfma_f32_32x32x16_bf16 v[128:143], a[56:59], v[92:95], v[128:143]
    ds_read_b64_tr_b16 a[180:181], v33 offset:24576
    ds_read_b64_tr_b16 a[182:183], v33 offset:25600
    ds_read_b64_tr_b16 a[176:177], v32 offset:24576
    ds_read_b64_tr_b16 a[178:179], v32 offset:25600
    s_waitcnt vmcnt(8)
    v_mfma_f32_32x32x16_bf16 v[144:159], a[68:71], v[96:99], v[144:159]
    buffer_load_dwordx4 v13, s[24:27], s67 offen offset:1024 lds
    s_add_u32 s6, s6, 9437184
    s_lshl_b32 s92, s89, 12
    v_mfma_f32_32x32x16_bf16 v[128:143], a[64:67], v[96:99], v[128:143]
    ds_read_b64_tr_b16 a[188:189], v33 offset:28672
    ds_read_b64_tr_b16 a[190:191], v33 offset:29696
    ds_read_b64_tr_b16 a[184:185], v32 offset:28672
    ds_read_b64_tr_b16 a[186:187], v32 offset:29696
    s_waitcnt vmcnt(8)
    v_mfma_f32_32x32x16_bf16 v[144:159], a[76:79], v[100:103], v[144:159]
    buffer_load_dwordx4 v14, s[24:27], s67 offen offset:2048 lds
    s_add_u32 s92, s92, 262144
    s_lshl_b32 s93, s89, 15
    v_mfma_f32_32x32x16_bf16 v[128:143], a[72:75], v[100:103], v[128:143]
    ds_read_b64_tr_b16 v[176:177], v46 offset:49152
    ds_read_b64_tr_b16 v[178:179], v46 offset:50688
    ds_read_b64_tr_b16 v[180:181], v46 offset:52224
    ds_read_b64_tr_b16 v[182:183], v46 offset:53760
    s_waitcnt vmcnt(8)
    v_mfma_f32_32x32x16_bf16 v[144:159], a[84:87], v[104:107], v[144:159]
    buffer_load_dwordx4 v15, s[24:27], s67 offen offset:3072 lds
    s_add_u32 s93, s93, 7340032
    v_lshlrev_b32 v40, 2, v1
    v_mfma_f32_32x32x16_bf16 v[128:143], a[80:83], v[104:107], v[128:143]
    ds_read_b64_tr_b16 v[184:185], v46 offset:55296
    ds_read_b64_tr_b16 v[186:187], v46 offset:56832
    ds_read_b64_tr_b16 v[188:189], v46 offset:58368
    ds_read_b64_tr_b16 v[190:191], v46 offset:59904
    s_waitcnt vmcnt(8)
    v_mfma_f32_32x32x16_bf16 v[144:159], a[92:95], v[108:111], v[144:159]
    s_waitcnt lgkmcnt(8)
    s_barrier
    s_add_u32 m0, s77, 98304
    s_add_u32 s67, s88, 1146880
    buffer_load_dwordx4 v12, s[24:27], s67 offen offset:0 lds
    v_mfma_f32_32x32x16_bf16 v[128:143], a[88:91], v[108:111], v[128:143]
    ds_read_b64_tr_b16 v[192:193], v46 offset:61440
    ds_read_b64_tr_b16 v[194:195], v46 offset:62976
    ds_read_b64_tr_b16 v[196:197], v46 offset:64512
    ds_read_b64_tr_b16 v[198:199], v47 offset:512
    s_waitcnt vmcnt(8)
    v_mfma_f32_32x32x16_bf16 v[144:159], a[100:103], v[112:115], v[144:159]
    buffer_load_dwordx4 v13, s[24:27], s67 offen offset:1024 lds
    v_mfma_f32_32x32x16_bf16 v[128:143], a[96:99], v[112:115], v[128:143]
    ds_read_b64_tr_b16 v[200:201], v47 offset:2048
    ds_read_b64_tr_b16 v[202:203], v47 offset:3584
    ds_read_b64_tr_b16 v[204:205], v47 offset:5120
    ds_read_b64_tr_b16 v[206:207], v47 offset:6656
    s_waitcnt vmcnt(8)
    v_mfma_f32_32x32x16_bf16 v[144:159], a[108:111], v[116:119], v[144:159]
    buffer_load_dwordx4 v14, s[24:27], s67 offen offset:2048 lds
    v_mfma_f32_32x32x16_bf16 v[128:143], a[104:107], v[116:119], v[128:143]
    ds_read_b64_tr_b16 v[208:209], v47 offset:8192
    ds_read_b64_tr_b16 v[210:211], v47 offset:9728
    ds_read_b64_tr_b16 v[212:213], v47 offset:11264
    ds_read_b64_tr_b16 v[214:215], v47 offset:12800
    s_waitcnt vmcnt(8)
    v_mfma_f32_32x32x16_bf16 v[144:159], a[116:119], v[120:123], v[144:159]
    buffer_load_dwordx4 v15, s[24:27], s67 offen offset:3072 lds
    v_mfma_f32_32x32x16_bf16 v[128:143], a[112:115], v[120:123], v[128:143]
    ds_read_b64_tr_b16 v[216:217], v47 offset:14336
    ds_read_b64_tr_b16 v[218:219], v47 offset:15872
    ds_read_b64_tr_b16 v[220:221], v47 offset:17408
    ds_read_b64_tr_b16 v[222:223], v47 offset:18944
    s_waitcnt vmcnt(8)
    v_mfma_f32_32x32x16_bf16 v[144:159], a[124:127], v[124:127], v[144:159]
    ds_read_b64_tr_b16 v[224:225], v47 offset:20480
    ds_read_b64_tr_b16 v[226:227], v47 offset:22016
    ds_read_b64_tr_b16 v[228:229], v47 offset:23552
    ds_read_b64_tr_b16 v[230:231], v47 offset:25088
    v_mfma_f32_32x32x16_bf16 v[128:143], a[120:123], v[124:127], v[128:143]
    ds_read_b64_tr_b16 v[232:233], v47 offset:26624
    ds_read_b64_tr_b16 v[234:235], v47 offset:28160
    ds_read_b64_tr_b16 v[236:237], v47 offset:29696
    ds_read_b64_tr_b16 v[238:239], v47 offset:31232
    s_nop 2
    ds_write_b128 v41, v[144:147] offset:0
    ds_write_b128 v41, v[148:151] offset:1024
    ds_write_b128 v41, v[152:155] offset:2048
    ds_write_b128 v41, v[156:159] offset:3072
    s_waitcnt lgkmcnt(0)
    s_barrier
    ds_read_b128 v[160:163], v42 offset:0
    ds_read_b128 v[164:167], v42 offset:1024
    ds_read_b128 v[168:171], v42 offset:2048
    ds_read_b128 v[172:175], v42 offset:3072
    s_waitcnt lgkmcnt(3)
    v_pk_add_f32 v[240:241], v[128:129], v[160:161]
    v_pk_add_f32 v[242:243], v[130:131], v[162:163]
    s_waitcnt lgkmcnt(2)
    v_pk_add_f32 v[244:245], v[132:133], v[164:165]
    v_pk_add_f32 v[246:247], v[134:135], v[166:167]
    v_cvt_pk_bf16_f32 v80, v240, v241
    v_cvt_pk_bf16_f32 v81, v242, v243
    v_cvt_pk_bf16_f32 v82, v244, v245
    v_cvt_pk_bf16_f32 v83, v246, v247
    buffer_store_dwordx4 v[80:83], v2, s[32:35], s94 offen offset:0 sc1
    s_waitcnt lgkmcnt(1)
    v_pk_add_f32 v[248:249], v[136:137], v[168:169]
    v_pk_add_f32 v[250:251], v[138:139], v[170:171]
    s_waitcnt lgkmcnt(0)
    s_nop 0
    v_pk_add_f32 v[252:253], v[140:141], v[172:173]
    v_pk_add_f32 v[254:255], v[142:143], v[174:175]
    v_cvt_pk_bf16_f32 v84, v248, v249
    v_cvt_pk_bf16_f32 v85, v250, v251
    v_cvt_pk_bf16_f32 v86, v252, v253
    v_cvt_pk_bf16_f32 v87, v254, v255
    buffer_store_dwordx4 v[84:87], v2, s[32:35], s94 offen offset:1024 sc1
    v_pk_add_f32 v[36:37], v[240:241], v[242:243]
    v_pk_mul_f32 v[38:39], v[240:241], v[240:241]
    v_pk_fma_f32 v[38:39], v[242:243], v[242:243], v[38:39]
    v_pk_add_f32 v[36:37], v[36:37], v[244:245]
    v_pk_fma_f32 v[38:39], v[244:245], v[244:245], v[38:39]
    v_pk_add_f32 v[36:37], v[36:37], v[246:247]
    v_pk_fma_f32 v[38:39], v[246:247], v[246:247], v[38:39]
    v_pk_add_f32 v[36:37], v[36:37], v[248:249]
    v_pk_fma_f32 v[38:39], v[248:249], v[248:249], v[38:39]
    v_pk_add_f32 v[36:37], v[36:37], v[250:251]
    v_pk_fma_f32 v[38:39], v[250:251], v[250:251], v[38:39]
    v_pk_add_f32 v[36:37], v[36:37], v[252:253]
    v_pk_fma_f32 v[38:39], v[252:253], v[252:253], v[38:39]
    v_pk_add_f32 v[36:37], v[36:37], v[254:255]
    v_pk_fma_f32 v[38:39], v[254:255], v[254:255], v[38:39]
    v_add_f32 v36, v36, v37
    v_add_f32 v38, v38, v39
    v_mov_b32 v16, 2
    v_mov_b32 v17, 3
    v_permlane32_swap_b32 v36, v38
    v_add_f32 v36, v36, v38
    buffer_store_dword v36, v40, s[32:35], s7 offen sc1
    v_dot2c_f32_bf16 v18, s60, v176
    v_dot2c_f32_bf16 v19, s60, v177
    v_dot2c_f32_bf16 v18, s60, v178
    v_dot2c_f32_bf16 v19, s60, v179
    v_dot2c_f32_bf16 v18, s60, v180
    v_dot2c_f32_bf16 v19, s60, v181
    v_dot2c_f32_bf16 v18, s60, v182
    v_dot2c_f32_bf16 v19, s60, v183
    v_dot2c_f32_bf16 v18, s60, v184
    v_dot2c_f32_bf16 v19, s60, v185
    v_dot2c_f32_bf16 v18, s60, v186
    v_dot2c_f32_bf16 v19, s60, v187
    v_dot2c_f32_bf16 v18, s60, v188
    v_dot2c_f32_bf16 v19, s60, v189
    v_dot2c_f32_bf16 v18, s60, v190
    v_dot2c_f32_bf16 v19, s60, v191
    v_dot2c_f32_bf16 v18, s60, v192
    v_dot2c_f32_bf16 v19, s60, v193
    v_dot2c_f32_bf16 v18, s60, v194
    v_dot2c_f32_bf16 v19, s60, v195
    v_dot2c_f32_bf16 v18, s60, v196
    v_dot2c_f32_bf16 v19, s60, v197
    v_dot2c_f32_bf16 v18, s60, v198
    v_dot2c_f32_bf16 v19, s60, v199
    v_dot2c_f32_bf16 v18, s60, v200
    v_dot2c_f32_bf16 v19, s60, v201
    v_dot2c_f32_bf16 v18, s60, v202
    v_dot2c_f32_bf16 v19, s60, v203
    v_dot2c_f32_bf16 v18, s60, v204
    v_dot2c_f32_bf16 v19, s60, v205
    v_dot2c_f32_bf16 v18, s60, v206
    v_dot2c_f32_bf16 v19, s60, v207
    v_dot2c_f32_bf16 v18, s60, v208
    v_dot2c_f32_bf16 v19, s60, v209
    v_dot2c_f32_bf16 v18, s60, v210
    v_dot2c_f32_bf16 v19, s60, v211
    v_dot2c_f32_bf16 v18, s60, v212
    v_dot2c_f32_bf16 v19, s60, v213
    v_dot2c_f32_bf16 v18, s60, v214
    v_dot2c_f32_bf16 v19, s60, v215
    v_dot2c_f32_bf16 v18, s60, v216
    v_dot2c_f32_bf16 v19, s60, v217
    v_dot2c_f32_bf16 v18, s60, v218
    v_dot2c_f32_bf16 v19, s60, v219
    v_dot2c_f32_bf16 v18, s60, v220
    v_dot2c_f32_bf16 v19, s60, v221
    v_dot2c_f32_bf16 v18, s60, v222
    v_dot2c_f32_bf16 v19, s60, v223
    v_dot2c_f32_bf16 v18, s60, v224
    v_dot2c_f32_bf16 v19, s60, v225
    v_dot2c_f32_bf16 v18, s60, v226
    v_dot2c_f32_bf16 v19, s60, v227
    v_dot2c_f32_bf16 v18, s60, v228
    v_dot2c_f32_bf16 v19, s60, v229
    v_dot2c_f32_bf16 v18, s60, v230
    v_dot2c_f32_bf16 v19, s60, v231
    v_dot2c_f32_bf16 v18, s60, v232
    v_dot2c_f32_bf16 v19, s60, v233
    v_dot2c_f32_bf16 v18, s60, v234
    v_dot2c_f32_bf16 v19, s60, v235
    v_dot2c_f32_bf16 v18, s60, v236
    v_dot2c_f32_bf16 v19, s60, v237
    v_dot2c_f32_bf16 v18, s60, v238
    v_dot2c_f32_bf16 v19, s60, v239
    v_lshlrev_b32 v44, 16, v0
    v_cmp_gt_u32 vcc, 32, v1
    v_lshlrev_b32 v45, 2, v20
    v_add_f32 v18, v18, v19
    v_mov_b32 v19, v18
    v_lshl_add_u32 v45, v21, 9, v45
    s_lshl_b32 s64, s81, 7
    s_add_u32 s64, s64, 147456
    v_permlane32_swap_b32 v18, v19
    v_add_f32 v18, v18, v19
    v_add_u32 v45, s64, v45
    v_cndmask_b32 v18, v44, v18, vcc
    s_add_u32 m0, s77, 114688
    s_add_u32 s67, s87, 32768
    buffer_load_dwordx4 v12, s[24:27], s67 offen offset:0 lds
    buffer_load_dwordx4 v13, s[24:27], s67 offen offset:1024 lds
    buffer_load_dwordx4 v14, s[24:27], s67 offen offset:2048 lds
    buffer_load_dwordx4 v15, s[24:27], s67 offen offset:3072 lds
    s_waitcnt vmcnt(4)
    s_cmp_lg_u32 s80, 0
    s_mov_b64 exec, 1
    s_cbranch_scc1 L_fl6
    buffer_store_dword v4, v5, s[32:35], s70 offen
L_fl6_r:
    s_mov_b64 exec, -1
    s_barrier
    buffer_load_dword v3, v29, s[32:35], s85 offen sc1
    ds_write_b32 v45, v18
    ds_read_b64_tr_b16 a[196:197], v33 offset:32768
    ds_read_b64_tr_b16 a[198:199], v33 offset:33792
    ds_read_b64_tr_b16 a[192:193], v32 offset:32768
    ds_read_b64_tr_b16 a[194:195], v32 offset:33792
    ds_read_b64_tr_b16 a[204:205], v33 offset:36864
    ds_read_b64_tr_b16 a[206:207], v33 offset:37888
    ds_read_b64_tr_b16 a[200:201], v32 offset:36864
    ds_read_b64_tr_b16 a[202:203], v32 offset:37888
    ds_read_b64_tr_b16 a[212:213], v33 offset:40960
    ds_read_b64_tr_b16 a[214:215], v33 offset:41984
    ds_read_b64_tr_b16 a[208:209], v32 offset:40960
    ds_read_b64_tr_b16 a[210:211], v32 offset:41984
    ds_read_b64_tr_b16 a[220:221], v33 offset:45056
    ds_read_b64_tr_b16 a[222:223], v33 offset:46080
    ds_read_b64_tr_b16 a[216:217], v32 offset:45056
    ds_read_b64_tr_b16 a[218:219], v32 offset:46080
    ds_read_b64_tr_b16 a[0:1], v31 offset:0
    ds_read_b64_tr_b16 a[2:3], v31 offset:1536
    ds_read_b64_tr_b16 a[4:5], v31 offset:64
    ds_read_b64_tr_b16 a[6:7], v31 offset:1600
    ds_read_b64_tr_b16 a[8:9], v31 offset:3072
    ds_read_b64_tr_b16 a[10:11], v31 offset:4608
    ds_read_b64_tr_b16 a[12:13], v31 offset:3136
    ds_read_b64_tr_b16 a[14:15], v31 offset:4672
    ds_read_b64_tr_b16 a[16:17], v31 offset:6144
    ds_read_b64_tr_b16 a[18:19], v31 offset:7680
    ds_read_b64_tr_b16 a[20:21], v31 offset:6208
    ds_read_b64_tr_b16 a[22:23], v31 offset:7744
    v_lshlrev_b32 v38, 16, v48
    v_and_b32 v39, s61, v48
    v_pk_add_f32 v[240:241], v[240:241], v[38:39]
    v_lshlrev_b32 v38, 16, v49
    v_and_b32 v39, s61, v49
    v_pk_add_f32 v[242:243], v[242:243], v[38:39]
    v_lshlrev_b32 v38, 16, v50
    v_and_b32 v39, s61, v50
    v_pk_add_f32 v[244:245], v[244:245], v[38:39]
    v_lshlrev_b32 v38, 16, v51
    v_and_b32 v39, s61, v51
    v_pk_add_f32 v[246:247], v[246:247], v[38:39]
    v_lshlrev_b32 v38, 16, v52
    v_and_b32 v39, s61, v52
    v_pk_add_f32 v[248:249], v[248:249], v[38:39]
    v_lshlrev_b32 v38, 16, v53
    v_and_b32 v39, s61, v53
    v_pk_add_f32 v[250:251], v[250:251], v[38:39]
    v_lshlrev_b32 v38, 16, v54
    v_and_b32 v39, s61, v54
    v_pk_add_f32 v[252:253], v[252:253], v[38:39]
    v_lshlrev_b32 v38, 16, v55
    v_and_b32 v39, s61, v55
    v_pk_add_f32 v[254:255], v[254:255], v[38:39]
    s_mov_b32 s72, 0
L_bp7:
    s_waitcnt vmcnt(0)
    v_cmp_gt_u32 vcc, 1, v3
    s_add_u32 s72, s72, 1
    s_bitcmp1_b32 s72, 20
    buffer_load_dword v3, v29, s[32:35], s85 offen sc1
    s_cbranch_scc1 L_bp7_x
    s_cbranch_vccnz L_bp7
L_bp7_x:
    buffer_load_dwordx4 a[64:67], v2, s[32:35], s93 offen offset:0 sc1
    buffer_load_dwordx4 a[68:71], v2, s[32:35], s93 offen offset:1024 sc1
    buffer_load_dwordx4 a[72:75], v2, s[32:35], s93 offen offset:2048 sc1
    buffer_load_dwordx4 a[76:79], v2, s[32:35], s93 offen offset:3072 sc1
    s_add_u32 s93, s93, 4096
    buffer_load_dwordx4 a[80:83], v2, s[32:35], s93 offen offset:0 sc1
    s_barrier
    ds_read_b64_tr_b16 a[228:229], v33 offset:0
    ds_read_b64_tr_b16 a[230:231], v33 offset:1024
    ds_read_b64_tr_b16 a[224:225], v32 offset:0
    ds_read_b64_tr_b16 a[226:227], v32 offset:1024
    ds_read_b64_tr_b16 a[236:237], v33 offset:4096
    ds_read_b64_tr_b16 a[238:239], v33 offset:5120
    ds_read_b64_tr_b16 a[232:233], v32 offset:4096
    ds_read_b64_tr_b16 a[234:235], v32 offset:5120
    buffer_load_dwordx4 a[84:87], v2, s[32:35], s93 offen offset:1024 sc1
    ds_read_b64_tr_b16 a[244:245], v33 offset:8192
    ds_read_b64_tr_b16 a[246:247], v33 offset:9216
    ds_read_b64_tr_b16 a[240:241], v32 offset:8192
    ds_read_b64_tr_b16 a[242:243], v32 offset:9216
    ds_read_b64_tr_b16 a[252:253], v33 offset:12288
    ds_read_b64_tr_b16 a[254:255], v33 offset:13312
    ds_read_b64_tr_b16 a[248:249], v32 offset:12288
    ds_read_b64_tr_b16 a[250:251], v32 offset:13312
    buffer_load_dwordx4 a[88:91], v2, s[32:35], s93 offen offset:2048 sc1
    ds_read_b64_tr_b16 a[36:37], v33 offset:16384
    ds_read_b64_tr_b16 a[38:39], v33 offset:17408
    ds_read_b64_tr_b16 a[32:33], v32 offset:16384
    ds_read_b64_tr_b16 a[34:35], v32 offset:17408
    ds_read_b64_tr_b16 a[44:45], v33 offset:20480
    ds_read_b64_tr_b16 a[46:47], v33 offset:21504
    ds_read_b64_tr_b16 a[40:41], v32 offset:20480
    ds_read_b64_tr_b16 a[42:43], v32 offset:21504
    buffer_load_dwordx4 a[92:95], v2, s[32:35], s93 offen offset:3072 sc1
    ds_read_b64_tr_b16 a[52:53], v33 offset:24576
    ds_read_b64_tr_b16 a[54:55], v33 offset:25600
    ds_read_b64_tr_b16 a[48:49], v32 offset:24576
    ds_read_b64_tr_b16 a[50:51], v32 offset:25600
    ds_read_b64_tr_b16 a[60:61], v33 offset:28672
    ds_read_b64_tr_b16 a[62:63], v33 offset:29696
    ds_read_b64_tr_b16 a[56:57], v32 offset:28672
    ds_read_b64_tr_b16 a[58:59], v32 offset:29696
    s_add_u32 s93, s93, 4096
    buffer_load_dwordx4 a[96:99], v2, s[32:35], s93 offen offset:0 sc1
    s_waitcnt vmcnt(8) lgkmcnt(14)
    v_mfma_f32_32x32x16_bf16 v[192:207], a[0:3], a[64:67], 0
    buffer_load_dwordx4 a[100:103], v2, s[32:35], s93 offen offset:1024 sc1
    ds_read_b64_tr_b16 a[24:25], v31 offset:9216
    ds_read_b64_tr_b16 a[26:27], v31 offset:10752
    v_mfma_f32_32x32x16_bf16 v[208:223], a[4:7], a[64:67], 0
    buffer_load_dwordx4 v[48:51], v2, s[32:35], s92 offen offset:0 sc1
    ds_read_b64_tr_b16 a[28:29], v31 offset:9280
    ds_read_b64_tr_b16 a[30:31], v31 offset:10816
    s_waitcnt vmcnt(9)
    v_mfma_f32_32x32x16_bf16 v[192:207], a[8:11], a[68:71], v[192:207]
    buffer_load_dwordx4 a[104:107], v2, s[32:35], s93 offen offset:2048 sc1
    ds_read_b64_tr_b16 a[0:1], v31 offset:12288
    ds_read_b64_tr_b16 a[2:3], v31 offset:13824
    v_mfma_f32_32x32x16_bf16 v[208:223], a[12:15], a[68:71], v[208:223]
    buffer_load_dwordx4 v[52:55], v2, s[32:35], s92 offen offset:1024 sc1
    ds_read_b64_tr_b16 a[4:5], v31 offset:12352
    ds_read_b64_tr_b16 a[6:7], v31 offset:13888
    v_and_b32 v43, 1, v1
    v_bfe_u32 v38, v1, 1, 1
    s_waitcnt vmcnt(10)
    v_mfma_f32_32x32x16_bf16 v[192:207], a[16:19], a[72:75], v[192:207]
    buffer_load_dwordx4 a[108:111], v2, s[32:35], s93 offen offset:3072 sc1
    ds_read_b64_tr_b16 a[8:9], v31 offset:15360
    ds_read_b64_tr_b16 a[10:11], v31 offset:16896
    v_mfma_f32_32x32x16_bf16 v[208:223], a[20:23], a[72:75], v[208:223]
    buffer_load_dwordx4 v[56:59], v2, s[32:35], s92 offen offset:2048 sc1
    ds_read_b64_tr_b16 a[12:13], v31 offset:15424
    ds_read_b64_tr_b16 a[14:15], v31 offset:16960
    v_lshl_add_u32 v43, v43, 1, v38
    v_bfe_u32 v38, v1, 2, 3
    s_waitcnt vmcnt(11) lgkmcnt(10)
    v_mfma_f32_32x32x16_bf16 v[192:207], a[24:27], a[76:79], v[192:207]
    s_add_u32 s93, s93, 4096
    buffer_load_dwordx4 a[112:115], v2, s[32:35], s93 offen offset:0 sc1
    ds_read_b64_tr_b16 a[16:17], v31 offset:18432
    ds_read_b64_tr_b16 a[18:19], v31 offset:19968
    s_waitcnt lgkmcnt(10)
    v_mfma_f32_32x32x16_bf16 v[208:223], a[28:31], a[76:79], v[208:223]
    buffer_load_dwordx4 v[60:63], v2, s[32:35], s92 offen offset:3072 sc1
    ds_read_b64_tr_b16 a[20:21], v31 offset:18496
    ds_read_b64_tr_b16 a[22:23], v31 offset:20032
    v_lshl_add_u32 v43, v43, 4, v38
    v_lshlrev_b32 v43, 2, v43
    s_waitcnt vmcnt(12) lgkmcnt(10)
    v_mfma_f32_32x32x16_bf16 v[192:207], a[0:3], a[80:83], v[192:207]
    buffer_load_dwordx4 a[116:119], v2, s[32:35], s93 offen offset:1024 sc1
    ds_read_b64_tr_b16 a[24:25], v31 offset:21504
    ds_read_b64_tr_b16 a[26:27], v31 offset:23040
    s_waitcnt lgkmcnt(10)
    v_mfma_f32_32x32x16_bf16 v[208:223], a[4:7], a[80:83], v[208:223]
    ds_read_b64_tr_b16 a[28:29], v31 offset:21568
    ds_read_b64_tr_b16 a[30:31], v31 offset:23104
    v_lshlrev_b32 v44, 4, v21
    v_add_u32 v44, 147456, v44
    s_waitcnt vmcnt(12) lgkmcnt(10)
    v_mfma_f32_32x32x16_bf16 v[192:207], a[8:11], a[84:87], v[192:207]
    buffer_load_dwordx4 a[120:123], v2, s[32:35], s93 offen offset:2048 sc1
    ds_read_b64_tr_b16 a[0:1], v31 offset:24576
    ds_read_b64_tr_b16 a[2:3], v31 offset:26112
    s_waitcnt lgkmcnt(10)
    v_mfma_f32_32x32x16_bf16 v[208:223], a[12:15], a[84:87], v[208:223]
    ds_read_b64_tr_b16 a[4:5], v31 offset:24640
    ds_read_b64_tr_b16 a[6:7], v31 offset:26176
    v_mov_b32 v42, 0xc0135761
    s_mov_b32 s78, 0xbdd2d3e8
    s_waitcnt vmcnt(12) lgkmcnt(10)
    v_mfma_f32_32x32x16_bf16 v[192:207], a[16:19], a[88:91], v[192:207]
    s_barrier
    buffer_load_dwordx4 a[124:127], v2, s[32:35], s93 offen offset:3072 sc1
    ds_read_b64_tr_b16 a[8:9], v31 offset:27648
    ds_read_b64_tr_b16 a[10:11], v31 offset:29184
    s_waitcnt lgkmcnt(10)
    v_mfma_f32_32x32x16_bf16 v[208:223], a[20:23], a[88:91], v[208:223]
    ds_read_b64_tr_b16 a[12:13], v31 offset:27712
    ds_read_b64_tr_b16 a[14:15], v31 offset:29248
    v_mul_u32_u24 v22, 45056, v8
    v_lshl_add_u32 v22, v9, 7, v22
    s_waitcnt vmcnt(12) lgkmcnt(10)
    v_mfma_f32_32x32x16_bf16 v[192:207], a[24:27], a[92:95], v[192:207]
    s_add_u32 s93, s93, 4096
    buffer_load_dwordx4 v[128:131], v2, s[32:35], s93 offen offset:0 sc1
    ds_read_b64_tr_b16 a[16:17], v31 offset:30720
    ds_read_b64_tr_b16 a[18:19], v31 offset:32256
    s_waitcnt lgkmcnt(10)
    v_mfma_f32_32x32x16_bf16 v[208:223], a[28:31], a[92:95], v[208:223]
    ds_read_b64_tr_b16 a[20:21], v31 offset:30784
    ds_read_b64_tr_b16 a[22:23], v31 offset:32320
    ds_read_b128 v[64:67], v44 offset:0
    ds_read_b128 v[80:83], v44 offset:512
    s_waitcnt vmcnt(12) lgkmcnt(12)
    v_mfma_f32_32x32x16_bf16 v[192:207], a[0:3], a[96:99], v[192:207]
    buffer_load_dwordx4 v[132:135], v2, s[32:35], s93 offen offset:1024 sc1
    ds_read_b64_tr_b16 a[24:25], v31 offset:33792
    ds_read_b64_tr_b16 a[26:27], v31 offset:35328
    s_waitcnt lgkmcnt(12)
    v_mfma_f32_32x32x16_bf16 v[208:223], a[4:7], a[96:99], v[208:223]
    ds_read_b64_tr_b16 a[28:29], v31 offset:33856
    ds_read_b64_tr_b16 a[30:31], v31 offset:35392
    ds_read_b128 v[68:71], v44 offset:32
    ds_read_b128 v[84:87], v44 offset:544
    s_waitcnt vmcnt(12) lgkmcnt(14)
    v_mfma_f32_32x32x16_bf16 v[192:207], a[8:11], a[100:103], v[192:207]
    buffer_load_dwordx4 v[136:139], v2, s[32:35], s93 offen offset:2048 sc1
    ds_read_b64_tr_b16 a[0:1], v31 offset:36864
    ds_read_b64_tr_b16 a[2:3], v31 offset:38400
    s_waitcnt lgkmcnt(14)
    v_mfma_f32_32x32x16_bf16 v[208:223], a[12:15], a[100:103], v[208:223]
    ds_read_b64_tr_b16 a[4:5], v31 offset:36928
    ds_read_b64_tr_b16 a[6:7], v31 offset:38464
    ds_read_b128 v[72:75], v44 offset:64
    ds_read_b128 v[88:91], v44 offset:576
    s_waitcnt vmcnt(11) lgkmcnt(14)
    v_mfma_f32_32x32x16_bf16 v[192:207], a[16:19], a[104:107], v[192:207]
    buffer_load_dwordx4 v[140:143], v2, s[32:35], s93 offen offset:3072 sc1
    ds_read_b64_tr_b16 a[8:9], v31 offset:39936
    ds_read_b64_tr_b16 a[10:11], v31 offset:41472
    v_mfma_f32_32x32x16_bf16 v[208:223], a[20:23], a[104:107], v[208:223]
    ds_read_b64_tr_b16 a[12:13], v31 offset:40000
    ds_read_b64_tr_b16 a[14:15], v31 offset:41536
    ds_read_b128 v[76:79], v44 offset:96
    ds_read_b128 v[92:95], v44 offset:608
    s_waitcnt vmcnt(10) lgkmcnt(14)
    v_mfma_f32_32x32x16_bf16 v[192:207], a[24:27], a[108:111], v[192:207]
    s_add_u32 s93, s93, 4096
    buffer_load_dwordx4 v[144:147], v2, s[32:35], s93 offen offset:0 sc1
    ds_read_b64_tr_b16 a[16:17], v31 offset:43008
    ds_read_b64_tr_b16 a[18:19], v31 offset:44544
    v_mfma_f32_32x32x16_bf16 v[208:223], a[28:31], a[108:111], v[208:223]
    ds_read_b64_tr_b16 a[20:21], v31 offset:43072
    ds_read_b64_tr_b16 a[22:23], v31 offset:44608
    ds_read_b128 v[96:99], v44 offset:128
    ds_read_b128 v[224:227], v44 offset:640
    s_waitcnt vmcnt(9) lgkmcnt(14)
    v_mfma_f32_32x32x16_bf16 v[192:207], a[0:3], a[112:115], v[192:207]
    buffer_load_dwordx4 v[148:151], v2, s[32:35], s93 offen offset:1024 sc1
    ds_read_b64_tr_b16 a[24:25], v31 offset:46080
    ds_read_b64_tr_b16 a[26:27], v31 offset:47616
    v_mfma_f32_32x32x16_bf16 v[208:223], a[4:7], a[112:115], v[208:223]
    ds_read_b64_tr_b16 a[28:29], v31 offset:46144
    ds_read_b64_tr_b16 a[30:31], v31 offset:47680
    ds_read_b128 v[100:103], v44 offset:160
    ds_read_b128 v[228:231], v44 offset:672
    s_waitcnt vmcnt(8) lgkmcnt(14)
    v_mfma_f32_32x32x16_bf16 v[192:207], a[8:11], a[116:119], v[192:207]
    buffer_load_dwordx4 v[152:155], v2, s[32:35], s93 offen offset:2048 sc1
    ds_read_b64_tr_b16 a[0:1], v31 offset:49152
    ds_read_b64_tr_b16 a[2:3], v31 offset:50688
    v_mfma_f32_32x32x16_bf16 v[208:223], a[12:15], a[116:119], v[208:223]
    ds_read_b64_tr_b16 a[4:5], v31 offset:49216
    ds_read_b64_tr_b16 a[6:7], v31 offset:50752
    ds_read_b128 v[104:107], v44 offset:192
    ds_read_b128 v[232:235], v44 offset:704
    s_waitcnt vmcnt(8) lgkmcnt(14)
    v_mfma_f32_32x32x16_bf16 v[192:207], a[16:19], a[120:123], v[192:207]
    buffer_load_dwordx4 v[156:159], v2, s[32:35], s93 offen offset:3072 sc1
    ds_read_b64_tr_b16 a[8:9], v31 offset:52224
    ds_read_b64_tr_b16 a[10:11], v31 offset:53760
    v_mfma_f32_32x32x16_bf16 v[208:223], a[20:23], a[120:123], v[208:223]
    ds_read_b64_tr_b16 a[12:13], v31 offset:52288
    ds_read_b64_tr_b16 a[14:15], v31 offset:53824
    ds_read_b128 v[108:111], v44 offset:224
    ds_read_b128 v[236:239], v44 offset:736
    s_waitcnt vmcnt(8) lgkmcnt(14)
    v_mfma_f32_32x32x16_bf16 v[192:207], a[24:27], a[124:127], v[192:207]
    s_add_u32 s93, s93, 4096
    buffer_load_dwordx4 v[160:163], v2, s[32:35], s93 offen offset:0 sc1
    ds_read_b64_tr_b16 a[16:17], v31 offset:55296
    ds_read_b64_tr_b16 a[18:19], v31 offset:56832
    v_mfma_f32_32x32x16_bf16 v[208:223], a[28:31], a[124:127], v[208:223]
    ds_read_b64_tr_b16 a[20:21], v31 offset:55360
    ds_read_b64_tr_b16 a[22:23], v31 offset:56896
    s_waitcnt vmcnt(8) lgkmcnt(14)
    v_mfma_f32_32x32x16_bf16 v[192:207], a[0:3], v[128:131], v[192:207]
    buffer_load_dwordx4 v[164:167], v2, s[32:35], s93 offen offset:1024 sc1
    ds_read_b64_tr_b16 a[24:25], v31 offset:58368
    ds_read_b64_tr_b16 a[26:27], v31 offset:59904
    s_waitcnt lgkmcnt(14)
    v_mfma_f32_32x32x16_bf16 v[208:223], a[4:7], v[128:131], v[208:223]
    ds_read_b64_tr_b16 a[28:29], v31 offset:58432
    ds_read_b64_tr_b16 a[30:31], v31 offset:59968
    v_add_f32 v48, v48, v52
    v_add_f32 v49, v49, v53
    s_waitcnt vmcnt(8) lgkmcnt(12)
    v_mfma_f32_32x32x16_bf16 v[192:207], a[8:11], v[132:135], v[192:207]
    buffer_load_dwordx4 v[168:171], v2, s[32:35], s93 offen offset:2048 sc1
    ds_read_b64_tr_b16 a[0:1], v31 offset:61440
    ds_read_b64_tr_b16 a[2:3], v31 offset:62976
    s_waitcnt lgkmcnt(12)
    v_mfma_f32_32x32x16_bf16 v[208:223], a[12:15], v[132:135], v[208:223]
    ds_read_b64_tr_b16 a[4:5], v31 offset:61504
    ds_read_b64_tr_b16 a[6:7], v31 offset:63040
    v_add_f32 v50, v50, v54
    v_add_f32 v51, v51, v55
    s_waitcnt vmcnt(8) lgkmcnt(10)
    v_mfma_f32_32x32x16_bf16 v[192:207], a[16:19], v[136:139], v[192:207]
    buffer_load_dwordx4 v[172:175], v2, s[32:35], s93 offen offset:3072 sc1
    ds_read_b64_tr_b16 a[8:9], v31 offset:64512
    ds_read_b64_tr_b16 a[10:11], v34 offset:512
    s_waitcnt lgkmcnt(10)
    v_mfma_f32_32x32x16_bf16 v[208:223], a[20:23], v[136:139], v[208:223]
    ds_read_b64_tr_b16 a[12:13], v31 offset:64576
    ds_read_b64_tr_b16 a[14:15], v34 offset:576
    v_add_f32 v48, v48, v56
    v_add_f32 v49, v49, v57
    s_waitcnt vmcnt(8) lgkmcnt(10)
    v_mfma_f32_32x32x16_bf16 v[192:207], a[24:27], v[140:143], v[192:207]
    s_add_u32 s93, s93, 4096
    buffer_load_dwordx4 v[176:179], v2, s[32:35], s93 offen offset:0 sc1
    ds_read_b64_tr_b16 a[16:17], v34 offset:2048
    ds_read_b64_tr_b16 a[18:19], v34 offset:3584
    s_waitcnt lgkmcnt(10)
    v_mfma_f32_32x32x16_bf16 v[208:223], a[28:31], v[140:143], v[208:223]
    ds_read_b64_tr_b16 a[20:21], v34 offset:2112
    ds_read_b64_tr_b16 a[22:23], v34 offset:3648
    v_add_f32 v50, v50, v58
    v_add_f32 v51, v51, v59
    s_waitcnt vmcnt(8) lgkmcnt(10)
    v_mfma_f32_32x32x16_bf16 v[192:207], a[0:3], v[144:147], v[192:207]
    buffer_load_dwordx4 v[180:183], v2, s[32:35], s93 offen offset:1024 sc1
    ds_read_b64_tr_b16 a[24:25], v34 offset:5120
    ds_read_b64_tr_b16 a[26:27], v34 offset:6656
    s_waitcnt lgkmcnt(10)
    v_mfma_f32_32x32x16_bf16 v[208:223], a[4:7], v[144:147], v[208:223]
    ds_read_b64_tr_b16 a[28:29], v34 offset:5184
    ds_read_b64_tr_b16 a[30:31], v34 offset:6720
    v_add_f32 v48, v48, v60
    v_add_f32 v49, v49, v61
    s_waitcnt vmcnt(8) lgkmcnt(10)
    v_mfma_f32_32x32x16_bf16 v[192:207], a[8:11], v[148:151], v[192:207]
    buffer_load_dwordx4 v[184:187], v2, s[32:35], s93 offen offset:2048 sc1
    ds_read_b64_tr_b16 a[0:1], v34 offset:8192
    ds_read_b64_tr_b16 a[2:3], v34 offset:9728
    s_waitcnt lgkmcnt(10)
    v_mfma_f32_32x32x16_bf16 v[208:223], a[12:15], v[148:151], v[208:223]
    ds_read_b64_tr_b16 a[4:5], v34 offset:8256
    ds_read_b64_tr_b16 a[6:7], v34 offset:9792
    v_add_f32 v50, v50, v62
    v_add_f32 v51, v51, v63
    s_waitcnt vmcnt(8) lgkmcnt(10)
    v_mfma_f32_32x32x16_bf16 v[192:207], a[16:19], v[152:155], v[192:207]
    buffer_load_dwordx4 v[188:191], v2, s[32:35], s93 offen offset:3072 sc1
    ds_read_b64_tr_b16 a[8:9], v34 offset:11264
    ds_read_b64_tr_b16 a[10:11], v34 offset:12800
    s_waitcnt lgkmcnt(10)
    v_mfma_f32_32x32x16_bf16 v[208:223], a[20:23], v[152:155], v[208:223]
    ds_read_b64_tr_b16 a[12:13], v34 offset:11328
    ds_read_b64_tr_b16 a[14:15], v34 offset:12864
    s_mov_b32 s65, 0x3727c5ac
    v_permlane32_swap_b32 v48, v49
    s_waitcnt vmcnt(8) lgkmcnt(10)
    v_mfma_f32_32x32x16_bf16 v[192:207], a[24:27], v[156:159], v[192:207]
    s_add_u32 m0, s77, 131072
    s_add_u32 s67, s87, 425984
    buffer_load_dwordx4 v12, s[24:27], s67 offen offset:0 lds
    ds_read_b64_tr_b16 a[16:17], v34 offset:14336
    ds_read_b64_tr_b16 a[18:19], v34 offset:15872
    s_waitcnt lgkmcnt(10)
    v_mfma_f32_32x32x16_bf16 v[208:223], a[28:31], v[156:159], v[208:223]
    ds_read_b64_tr_b16 a[20:21], v34 offset:14400
    ds_read_b64_tr_b16 a[22:23], v34 offset:15936
    v_permlane32_swap_b32 v50, v51
    v_add_f32 v48, v48, v49
    s_waitcnt vmcnt(8) lgkmcnt(10)
    v_mfma_f32_32x32x16_bf16 v[192:207], a[0:3], v[160:163], v[192:207]
    buffer_load_dwordx4 v13, s[24:27], s67 offen offset:1024 lds
    ds_read_b64_tr_b16 a[24:25], v34 offset:17408
    ds_read_b64_tr_b16 a[26:27], v34 offset:18944
    s_waitcnt lgkmcnt(10)
    v_mfma_f32_32x32x16_bf16 v[208:223], a[4:7], v[160:163], v[208:223]
    ds_read_b64_tr_b16 a[28:29], v34 offset:17472
    ds_read_b64_tr_b16 a[30:31], v34 offset:19008
    v_add_f32 v50, v50, v51
    v_add_u32 v56, 45056, v10
    s_waitcnt vmcnt(8) lgkmcnt(10)
    v_mfma_f32_32x32x16_bf16 v[192:207], a[8:11], v[164:167], v[192:207]
    buffer_load_dwordx4 v14, s[24:27], s67 offen offset:2048 lds
    ds_read_b64_tr_b16 a[0:1], v34 offset:20480
    ds_read_b64_tr_b16 a[2:3], v34 offset:22016
    s_waitcnt lgkmcnt(10)
    v_mfma_f32_32x32x16_bf16 v[208:223], a[12:15], v[164:167], v[208:223]
    ds_read_b64_tr_b16 a[4:5], v34 offset:20544
    ds_read_b64_tr_b16 a[6:7], v34 offset:22080
    v_permlane16_swap_b32 v48, v50
    v_add_f32 v48, v48, v50
    s_waitcnt vmcnt(8) lgkmcnt(10)
    v_mfma_f32_32x32x16_bf16 v[192:207], a[16:19], v[168:171], v[192:207]
    buffer_load_dwordx4 v15, s[24:27], s67 offen offset:3072 lds
    ds_read_b64_tr_b16 a[8:9], v34 offset:23552
    ds_read_b64_tr_b16 a[10:11], v34 offset:25088
    s_waitcnt lgkmcnt(10)
    v_mfma_f32_32x32x16_bf16 v[208:223], a[20:23], v[168:171], v[208:223]
    ds_read_b64_tr_b16 a[12:13], v34 offset:23616
    ds_read_b64_tr_b16 a[14:15], v34 offset:25152
    v_mul_f32 v48, 0x3b000000, v48
    ds_bpermute_b32 v36, v43, v48
    s_waitcnt vmcnt(8) lgkmcnt(11)
    v_mfma_f32_32x32x16_bf16 v[192:207], a[24:27], v[172:175], v[192:207]
    s_add_u32 m0, s77, 98304
    s_add_u32 s67, s87, 819200
    buffer_load_dwordx4 v12, s[24:27], s67 offen offset:0 lds
    ds_read_b64_tr_b16 a[16:17], v34 offset:26624
    ds_read_b64_tr_b16 a[18:19], v34 offset:28160
    s_waitcnt lgkmcnt(11)
    v_mfma_f32_32x32x16_bf16 v[208:223], a[28:31], v[172:175], v[208:223]
    ds_read_b64_tr_b16 a[20:21], v34 offset:26688
    ds_read_b64_tr_b16 a[22:23], v34 offset:28224
    ds_bpermute_b32 v38, v43, v48 offset:32
    s_waitcnt vmcnt(8) lgkmcnt(12)
    v_mfma_f32_32x32x16_bf16 v[192:207], a[0:3], v[176:179], v[192:207]
    buffer_load_dwordx4 v13, s[24:27], s67 offen offset:1024 lds
    ds_read_b64_tr_b16 a[24:25], v34 offset:29696
    ds_read_b64_tr_b16 a[26:27], v34 offset:31232
    s_waitcnt lgkmcnt(12)
    v_mfma_f32_32x32x16_bf16 v[208:223], a[4:7], v[176:179], v[208:223]
    ds_read_b64_tr_b16 a[28:29], v34 offset:29760
    ds_read_b64_tr_b16 a[30:31], v34 offset:31296
    s_waitcnt vmcnt(8) lgkmcnt(12)
    v_mfma_f32_32x32x16_bf16 v[192:207], a[8:11], v[180:183], v[192:207]
    buffer_load_dwordx4 v14, s[24:27], s67 offen offset:2048 lds
    ds_read_b64_tr_b16 a[0:1], v31 offset:128
    ds_read_b64_tr_b16 a[2:3], v31 offset:1664
    s_waitcnt lgkmcnt(12)
    v_mfma_f32_32x32x16_bf16 v[208:223], a[12:15], v[180:183], v[208:223]
    ds_read_b64_tr_b16 a[4:5], v31 offset:3200
    ds_read_b64_tr_b16 a[6:7], v31 offset:4736
    s_waitcnt vmcnt(8) lgkmcnt(11)
    v_mfma_f32_32x32x16_bf16 v[192:207], a[16:19], v[184:187], v[192:207]
    buffer_load_dwordx4 v15, s[24:27], s67 offen offset:3072 lds
    ds_read_b64_tr_b16 a[8:9], v31 offset:6272
    ds_read_b64_tr_b16 a[10:11], v31 offset:7808
    s_waitcnt lgkmcnt(11)
    v_mfma_f32_32x32x16_bf16 v[208:223], a[20:23], v[184:187], v[208:223]
    ds_read_b64_tr_b16 a[12:13], v31 offset:9344
    ds_read_b64_tr_b16 a[14:15], v31 offset:10880
    s_waitcnt vmcnt(8) lgkmcnt(10)
    v_mfma_f32_32x32x16_bf16 v[192:207], a[24:27], v[188:191], v[192:207]
    ds_read_b64_tr_b16 a[16:17], v31 offset:12416
    ds_read_b64_tr_b16 a[18:19], v31 offset:13952
    s_waitcnt lgkmcnt(10)
    v_mfma_f32_32x32x16_bf16 v[208:223], a[28:31], v[188:191], v[208:223]
    ds_read_b64_tr_b16 a[20:21], v31 offset:15488
    ds_read_b64_tr_b16 a[22:23], v31 offset:17024
    v_fma_f32 v38, -v36, v36, v38
    v_max_f32 v38, 0, v38
    v_add_f32 v39, s65, v38
    v_rsq_f32 v39, v39
    s_nop 0
    v_mul_f32 v38, v38, v39
    v_fma_f32 v38, v38, v39, s65
    v_rsq_f32 v38, v38
    s_nop 0
    v_mul_f32_e64 v37, v38, v39
    v_mul_f32_e64 v36, -v36, v37
    v_pk_fma_f32 v[224:225], v[96:97], v[36:37], v[224:225] op_sel_hi:[1,0,1]
    v_pk_fma_f32 v[226:227], v[98:99], v[36:37], v[226:227] op_sel_hi:[1,0,1]
    v_pk_fma_f32 v[228:229], v[100:101], v[36:37], v[228:229] op_sel_hi:[1,0,1]
    v_pk_fma_f32 v[230:231], v[102:103], v[36:37], v[230:231] op_sel_hi:[1,0,1]
    v_pk_fma_f32 v[232:233], v[104:105], v[36:37], v[232:233] op_sel_hi:[1,0,1]
    v_pk_fma_f32 v[234:235], v[106:107], v[36:37], v[234:235] op_sel_hi:[1,0,1]
    v_pk_fma_f32 v[236:237], v[108:109], v[36:37], v[236:237] op_sel_hi:[1,0,1]
    v_pk_fma_f32 v[238:239], v[110:111], v[36:37], v[238:239] op_sel_hi:[1,0,1]
    v_pk_fma_f32 v[80:81], v[64:65], v[36:37], v[80:81] op_sel_hi:[1,0,1]
    v_pk_fma_f32 v[82:83], v[66:67], v[36:37], v[82:83] op_sel_hi:[1,0,1]
    v_pk_fma_f32 v[84:85], v[68:69], v[36:37], v[84:85] op_sel_hi:[1,0,1]
    v_pk_fma_f32 v[86:87], v[70:71], v[36:37], v[86:87] op_sel_hi:[1,0,1]
    v_pk_fma_f32 v[88:89], v[72:73], v[36:37], v[88:89] op_sel_hi:[1,0,1]
    v_pk_fma_f32 v[90:91], v[74:75], v[36:37], v[90:91] op_sel_hi:[1,0,1]
    v_pk_fma_f32 v[92:93], v[76:77], v[36:37], v[92:93] op_sel_hi:[1,0,1]
    v_pk_fma_f32 v[94:95], v[78:79], v[36:37], v[94:95] op_sel_hi:[1,0,1]
    v_pk_fma_f32 v[192:193], v[192:193], v[36:37], v[80:81] op_sel:[0,1,0] op_sel_hi:[1,1,1]
    v_pk_fma_f32 v[194:195], v[194:195], v[36:37], v[82:83] op_sel:[0,1,0] op_sel_hi:[1,1,1]
    v_pk_fma_f32 v[196:197], v[196:197], v[36:37], v[84:85] op_sel:[0,1,0] op_sel_hi:[1,1,1]
    v_pk_fma_f32 v[198:199], v[198:199], v[36:37], v[86:87] op_sel:[0,1,0] op_sel_hi:[1,1,1]
    v_pk_fma_f32 v[200:201], v[200:201], v[36:37], v[88:89] op_sel:[0,1,0] op_sel_hi:[1,1,1]
    v_pk_fma_f32 v[202:203], v[202:203], v[36:37], v[90:91] op_sel:[0,1,0] op_sel_hi:[1,1,1]
    v_pk_fma_f32 v[204:205], v[204:205], v[36:37], v[92:93] op_sel:[0,1,0] op_sel_hi:[1,1,1]
    v_pk_fma_f32 v[206:207], v[206:207], v[36:37], v[94:95] op_sel:[0,1,0] op_sel_hi:[1,1,1]
    s_add_u32 m0, s77, 114688
    s_add_u32 s67, s88, 1179648
    buffer_load_dwordx4 v12, s[24:27], s67 offen offset:0 lds
    v_pk_mul_f32 v[96:97], v[192:193], v[192:193]
    v_pk_mul_f32 v[98:99], v[194:195], v[194:195]
    v_pk_mul_f32 v[100:101], v[196:197], v[196:197]
    v_pk_mul_f32 v[102:103], v[198:199], v[198:199]
    v_pk_mul_f32 v[104:105], v[200:201], v[200:201]
    v_pk_mul_f32 v[106:107], v[202:203], v[202:203]
    v_pk_mul_f32 v[108:109], v[204:205], v[204:205]
    v_pk_mul_f32 v[110:111], v[206:207], v[206:207]
    v_pk_fma_f32 v[96:97], v[96:97], s[78:79], v[42:43] op_sel_hi:[1,0,0]
    v_pk_fma_f32 v[98:99], v[98:99], s[78:79], v[42:43] op_sel_hi:[1,0,0]
    v_pk_fma_f32 v[100:101], v[100:101], s[78:79], v[42:43] op_sel_hi:[1,0,0]
    v_pk_fma_f32 v[102:103], v[102:103], s[78:79], v[42:43] op_sel_hi:[1,0,0]
    v_pk_fma_f32 v[104:105], v[104:105], s[78:79], v[42:43] op_sel_hi:[1,0,0]
    v_pk_fma_f32 v[106:107], v[106:107], s[78:79], v[42:43] op_sel_hi:[1,0,0]
    v_pk_fma_f32 v[108:109], v[108:109], s[78:79], v[42:43] op_sel_hi:[1,0,0]
    v_pk_fma_f32 v[110:111], v[110:111], s[78:79], v[42:43] op_sel_hi:[1,0,0]
    buffer_load_dwordx4 v13, s[24:27], s67 offen offset:1024 lds
    v_pk_mul_f32 v[96:97], v[96:97], v[192:193]
    v_pk_mul_f32 v[98:99], v[98:99], v[194:195]
    v_pk_mul_f32 v[100:101], v[100:101], v[196:197]
    v_pk_mul_f32 v[102:103], v[102:103], v[198:199]
    v_pk_mul_f32 v[104:105], v[104:105], v[200:201]
    v_pk_mul_f32 v[106:107], v[106:107], v[202:203]
    v_pk_mul_f32 v[108:109], v[108:109], v[204:205]
    v_pk_mul_f32 v[110:111], v[110:111], v[206:207]
    v_exp_f32 v96, v96
    v_exp_f32 v97, v97
    v_exp_f32 v98, v98
    v_exp_f32 v99, v99
    buffer_load_dwordx4 v14, s[24:27], s67 offen offset:2048 lds
    v_exp_f32 v100, v100
    v_exp_f32 v101, v101
    v_exp_f32 v102, v102
    v_exp_f32 v103, v103
    v_exp_f32 v104, v104
    v_exp_f32 v105, v105
    v_exp_f32 v106, v106
    v_exp_f32 v107, v107
    buffer_load_dwordx4 v15, s[24:27], s67 offen offset:3072 lds
    v_exp_f32 v108, v108
    v_exp_f32 v109, v109
    v_exp_f32 v110, v110
    v_exp_f32 v111, v111
    v_pk_add_f32 v[96:97], v[96:97], 1.0 op_sel_hi:[1,0]
    v_pk_add_f32 v[98:99], v[98:99], 1.0 op_sel_hi:[1,0]
    v_pk_add_f32 v[100:101], v[100:101], 1.0 op_sel_hi:[1,0]
    v_pk_add_f32 v[102:103], v[102:103], 1.0 op_sel_hi:[1,0]
    v_pk_add_f32 v[104:105], v[104:105], 1.0 op_sel_hi:[1,0]
    v_pk_add_f32 v[106:107], v[106:107], 1.0 op_sel_hi:[1,0]
    v_pk_add_f32 v[108:109], v[108:109], 1.0 op_sel_hi:[1,0]
    v_pk_add_f32 v[110:111], v[110:111], 1.0 op_sel_hi:[1,0]
    v_rcp_f32 v96, v96
    v_rcp_f32 v97, v97
    v_rcp_f32 v98, v98
    v_rcp_f32 v99, v99
    v_rcp_f32 v100, v100
    v_rcp_f32 v101, v101
    v_rcp_f32 v102, v102
    v_rcp_f32 v103, v103
    v_pk_mul_f32 v[96:97], v[96:97], v[192:193]
    v_pk_mul_f32 v[98:99], v[98:99], v[194:195]
    v_pk_mul_f32 v[100:101], v[100:101], v[196:197]
    v_pk_mul_f32 v[102:103], v[102:103], v[198:199]
    v_cvt_pk_bf16_f32 v112, v96, v97
    v_cvt_pk_bf16_f32 v113, v98, v99
    v_cvt_pk_bf16_f32 v114, v100, v101
    v_cvt_pk_bf16_f32 v115, v102, v103
    buffer_store_dwordx4 v[112:115], v2, s[32:35], s6 offen sc1
    v_rcp_f32 v104, v104
    v_rcp_f32 v105, v105
    v_rcp_f32 v106, v106
    v_rcp_f32 v107, v107
    v_rcp_f32 v108, v108
    v_rcp_f32 v109, v109
    v_rcp_f32 v110, v110
    v_rcp_f32 v111, v111
    v_pk_mul_f32 v[104:105], v[104:105], v[200:201]
    v_pk_mul_f32 v[106:107], v[106:107], v[202:203]
    v_pk_mul_f32 v[108:109], v[108:109], v[204:205]
    v_pk_mul_f32 v[110:111], v[110:111], v[206:207]
    v_cvt_pk_bf16_f32 v116, v104, v105
    v_cvt_pk_bf16_f32 v117, v106, v107
    v_cvt_pk_bf16_f32 v118, v108, v109
    v_cvt_pk_bf16_f32 v119, v110, v111
    buffer_store_dwordx4 v[116:119], v28, s[32:35], s6 offen sc1
    s_add_u32 s6, s6, 16384
    v_pk_fma_f32 v[208:209], v[208:209], v[36:37], v[224:225] op_sel:[0,1,0] op_sel_hi:[1,1,1]
    v_pk_fma_f32 v[210:211], v[210:211], v[36:37], v[226:227] op_sel:[0,1,0] op_sel_hi:[1,1,1]
    v_pk_fma_f32 v[212:213], v[212:213], v[36:37], v[228:229] op_sel:[0,1,0] op_sel_hi:[1,1,1]
    v_pk_fma_f32 v[214:215], v[214:215], v[36:37], v[230:231] op_sel:[0,1,0] op_sel_hi:[1,1,1]
    v_pk_fma_f32 v[216:217], v[216:217], v[36:37], v[232:233] op_sel:[0,1,0] op_sel_hi:[1,1,1]
    v_pk_fma_f32 v[218:219], v[218:219], v[36:37], v[234:235] op_sel:[0,1,0] op_sel_hi:[1,1,1]
    v_pk_fma_f32 v[220:221], v[220:221], v[36:37], v[236:237] op_sel:[0,1,0] op_sel_hi:[1,1,1]
    v_pk_fma_f32 v[222:223], v[222:223], v[36:37], v[238:239] op_sel:[0,1,0] op_sel_hi:[1,1,1]
    v_pk_mul_f32 v[96:97], v[208:209], v[208:209]
    v_pk_mul_f32 v[98:99], v[210:211], v[210:211]
    v_pk_mul_f32 v[100:101], v[212:213], v[212:213]
    v_pk_mul_f32 v[102:103], v[214:215], v[214:215]
    v_pk_mul_f32 v[104:105], v[216:217], v[216:217]
    v_pk_mul_f32 v[106:107], v[218:219], v[218:219]
    v_pk_mul_f32 v[108:109], v[220:221], v[220:221]
    v_pk_mul_f32 v[110:111], v[222:223], v[222:223]
    v_pk_fma_f32 v[96:97], v[96:97], s[78:79], v[42:43] op_sel_hi:[1,0,0]
    v_pk_fma_f32 v[98:99], v[98:99], s[78:79], v[42:43] op_sel_hi:[1,0,0]
    v_pk_fma_f32 v[100:101], v[100:101], s[78:79], v[42:43] op_sel_hi:[1,0,0]
    v_pk_fma_f32 v[102:103], v[102:103], s[78:79], v[42:43] op_sel_hi:[1,0,0]
    v_pk_fma_f32 v[104:105], v[104:105], s[78:79], v[42:43] op_sel_hi:[1,0,0]
    v_pk_fma_f32 v[106:107], v[106:107], s[78:79], v[42:43] op_sel_hi:[1,0,0]
    v_pk_fma_f32 v[108:109], v[108:109], s[78:79], v[42:43] op_sel_hi:[1,0,0]
    v_pk_fma_f32 v[110:111], v[110:111], s[78:79], v[42:43] op_sel_hi:[1,0,0]
    v_pk_mul_f32 v[96:97], v[96:97], v[208:209]
    v_pk_mul_f32 v[98:99], v[98:99], v[210:211]
    v_pk_mul_f32 v[100:101], v[100:101], v[212:213]
    v_pk_mul_f32 v[102:103], v[102:103], v[214:215]
    v_pk_mul_f32 v[104:105], v[104:105], v[216:217]
    v_pk_mul_f32 v[106:107], v[106:107], v[218:219]
    v_pk_mul_f32 v[108:109], v[108:109], v[220:221]
    v_pk_mul_f32 v[110:111], v[110:111], v[222:223]
    v_exp_f32 v96, v96
    v_exp_f32 v97, v97
    v_exp_f32 v98, v98
    v_exp_f32 v99, v99
    v_exp_f32 v100, v100
    v_exp_f32 v101, v101
    v_exp_f32 v102, v102
    v_exp_f32 v103, v103
    v_exp_f32 v104, v104
    v_exp_f32 v105, v105
    v_exp_f32 v106, v106
    v_exp_f32 v107, v107
    v_exp_f32 v108, v108
    v_exp_f32 v109, v109
    v_exp_f32 v110, v110
    v_exp_f32 v111, v111
    v_pk_add_f32 v[96:97], v[96:97], 1.0 op_sel_hi:[1,0]
    v_pk_add_f32 v[98:99], v[98:99], 1.0 op_sel_hi:[1,0]
    v_pk_add_f32 v[100:101], v[100:101], 1.0 op_sel_hi:[1,0]
    v_pk_add_f32 v[102:103], v[102:103], 1.0 op_sel_hi:[1,0]
    v_pk_add_f32 v[104:105], v[104:105], 1.0 op_sel_hi:[1,0]
    v_pk_add_f32 v[106:107], v[106:107], 1.0 op_sel_hi:[1,0]
    v_pk_add_f32 v[108:109], v[108:109], 1.0 op_sel_hi:[1,0]
    v_pk_add_f32 v[110:111], v[110:111], 1.0 op_sel_hi:[1,0]
    v_rcp_f32 v96, v96
    v_rcp_f32 v97, v97
    v_rcp_f32 v98, v98
    v_rcp_f32 v99, v99
    v_rcp_f32 v100, v100
    v_rcp_f32 v101, v101
    v_rcp_f32 v102, v102
    v_rcp_f32 v103, v103
    v_pk_mul_f32 v[96:97], v[96:97], v[208:209]
    v_pk_mul_f32 v[98:99], v[98:99], v[210:211]
    v_pk_mul_f32 v[100:101], v[100:101], v[212:213]
    v_pk_mul_f32 v[102:103], v[102:103], v[214:215]
    v_cvt_pk_bf16_f32 v120, v96, v97
    v_cvt_pk_bf16_f32 v121, v98, v99
    v_cvt_pk_bf16_f32 v122, v100, v101
    v_cvt_pk_bf16_f32 v123, v102, v103
    buffer_store_dwordx4 v[120:123], v2, s[32:35], s6 offen sc1
    v_rcp_f32 v104, v104
    v_rcp_f32 v105, v105
    v_rcp_f32 v106, v106
    v_rcp_f32 v107, v107
    v_rcp_f32 v108, v108
    v_rcp_f32 v109, v109
    v_rcp_f32 v110, v110
    v_rcp_f32 v111, v111
    v_pk_mul_f32 v[104:105], v[104:105], v[216:217]
    v_pk_mul_f32 v[106:107], v[106:107], v[218:219]
    v_pk_mul_f32 v[108:109], v[108:109], v[220:221]
    v_pk_mul_f32 v[110:111], v[110:111], v[222:223]
    v_cvt_pk_bf16_f32 v124, v104, v105
    v_cvt_pk_bf16_f32 v125, v106, v107
    v_cvt_pk_bf16_f32 v126, v108, v109
    v_cvt_pk_bf16_f32 v127, v110, v111
    buffer_store_dwordx4 v[124:127], v28, s[32:35], s6 offen sc1
    s_add_u32 s6, s6, 16384
    s_waitcnt lgkmcnt(10)
    v_mfma_f32_32x32x16_bf16 v[224:239], a[0:3], a[64:67], 0
    ds_read_b64_tr_b16 a[24:25], v31 offset:18560
    ds_read_b64_tr_b16 a[26:27], v31 offset:20096
    ds_read_b128 v[64:67], v44 offset:256
    ds_read_b128 v[80:83], v44 offset:768
    s_waitcnt lgkmcnt(12)
    v_mfma_f32_32x32x16_bf16 v[224:239], a[4:7], a[68:71], v[224:239]
    ds_read_b64_tr_b16 a[28:29], v31 offset:21632
    ds_read_b64_tr_b16 a[30:31], v31 offset:23168
    ds_read_b128 v[68:71], v44 offset:288
    ds_read_b128 v[84:87], v44 offset:800
    s_waitcnt lgkmcnt(14)
    v_mfma_f32_32x32x16_bf16 v[224:239], a[8:11], a[72:75], v[224:239]
    ds_read_b64_tr_b16 a[0:1], v31 offset:24704
    ds_read_b64_tr_b16 a[2:3], v31 offset:26240
    ds_read_b128 v[72:75], v44 offset:320
    ds_read_b128 v[88:91], v44 offset:832
    s_waitcnt lgkmcnt(14)
    v_mfma_f32_32x32x16_bf16 v[224:239], a[12:15], a[76:79], v[224:239]
    ds_read_b64_tr_b16 a[4:5], v31 offset:27776
    ds_read_b64_tr_b16 a[6:7], v31 offset:29312
    ds_read_b128 v[76:79], v44 offset:352
    ds_read_b128 v[92:95], v44 offset:864
    v_mfma_f32_32x32x16_bf16 v[224:239], a[16:19], a[80:83], v[224:239]
    ds_read_b64_tr_b16 a[8:9], v31 offset:30848
    ds_read_b64_tr_b16 a[10:11], v31 offset:32384
    s_waitcnt lgkmcnt(14)
    v_mfma_f32_32x32x16_bf16 v[224:239], a[20:23], a[84:87], v[224:239]
    ds_read_b64_tr_b16 a[12:13], v31 offset:33920
    ds_read_b64_tr_b16 a[14:15], v31 offset:35456
    v_mfma_f32_32x32x16_bf16 v[224:239], a[24:27], a[88:91], v[224:239]
    ds_read_b64_tr_b16 a[16:17], v31 offset:36992
    ds_read_b64_tr_b16 a[18:19], v31 offset:38528
    v_fmac_f32 v80, v64, v36
    v_fmac_f32 v81, v65, v36
    s_waitcnt lgkmcnt(14)
    v_mfma_f32_32x32x16_bf16 v[224:239], a[28:31], a[92:95], v[224:239]
    ds_read_b64_tr_b16 a[20:21], v31 offset:40064
    ds_read_b64_tr_b16 a[22:23], v31 offset:41600
    v_fmac_f32 v82, v66, v36
    v_fmac_f32 v83, v67, v36
    s_waitcnt lgkmcnt(14)
    v_mfma_f32_32x32x16_bf16 v[224:239], a[0:3], a[96:99], v[224:239]
    ds_read_b64_tr_b16 a[24:25], v31 offset:43136
    ds_read_b64_tr_b16 a[26:27], v31 offset:44672
    v_fmac_f32 v84, v68, v36
    v_fmac_f32 v85, v69, v36
    s_waitcnt lgkmcnt(12)
    v_mfma_f32_32x32x16_bf16 v[224:239], a[4:7], a[100:103], v[224:239]
    s_sub_u32 s64, s6, 32768
    s_waitcnt vmcnt(2)
    s_cmp_lg_u32 s80, 0
    s_mov_b64 exec, 1
    s_cbranch_scc1 L_fl8
    buffer_store_dword v4, v5, s[32:35], s71 offen
L_fl8_r:
    s_mov_b64 exec, -1
    ds_read_b64_tr_b16 a[28:29], v31 offset:46208
    ds_read_b64_tr_b16 a[30:31], v31 offset:47744
    v_fmac_f32 v86, v70, v36
    v_fmac_f32 v87, v71, v36
    s_waitcnt lgkmcnt(10)
    v_mfma_f32_32x32x16_bf16 v[224:239], a[8:11], a[104:107], v[224:239]
    ds_read_b64_tr_b16 a[0:1], v31 offset:49280
    ds_read_b64_tr_b16 a[2:3], v31 offset:50816
    v_fmac_f32 v88, v72, v36
    v_fmac_f32 v89, v73, v36
    s_waitcnt lgkmcnt(10)
    v_mfma_f32_32x32x16_bf16 v[224:239], a[12:15], a[108:111], v[224:239]
    ds_read_b64_tr_b16 a[4:5], v31 offset:52352
    ds_read_b64_tr_b16 a[6:7], v31 offset:53888
    v_fmac_f32 v90, v74, v36
    v_fmac_f32 v91, v75, v36
    s_waitcnt lgkmcnt(10)
    v_mfma_f32_32x32x16_bf16 v[224:239], a[16:19], a[112:115], v[224:239]
    s_barrier
    s_add_u32 m0, s77, 0
    s_add_u32 s67, s87, 65536
    buffer_load_dwordx4 v12, s[24:27], s67 offen offset:0 lds
    ds_read_b64_tr_b16 a[8:9], v31 offset:55424
    ds_read_b64_tr_b16 a[10:11], v31 offset:56960
    v_fmac_f32 v92, v76, v36
    v_fmac_f32 v93, v77, v36
    s_waitcnt lgkmcnt(10)
    v_mfma_f32_32x32x16_bf16 v[224:239], a[20:23], a[116:119], v[224:239]
    ds_read_b64_tr_b16 a[12:13], v31 offset:58496
    ds_read_b64_tr_b16 a[14:15], v31 offset:60032
    v_fmac_f32 v94, v78, v36
    v_fmac_f32 v95, v79, v36
    s_waitcnt lgkmcnt(10)
    v_mfma_f32_32x32x16_bf16 v[224:239], a[24:27], a[120:123], v[224:239]
    buffer_load_dwordx4 v13, s[24:27], s67 offen offset:1024 lds
    ds_read_b64_tr_b16 a[16:17], v31 offset:61568
    ds_read_b64_tr_b16 a[18:19], v31 offset:63104
    s_waitcnt lgkmcnt(10)
    v_mfma_f32_32x32x16_bf16 v[224:239], a[28:31], a[124:127], v[224:239]
    ds_read_b64_tr_b16 a[20:21], v31 offset:64640
    ds_read_b64_tr_b16 a[22:23], v34 offset:640
    s_waitcnt lgkmcnt(10)
    v_mfma_f32_32x32x16_bf16 v[224:239], a[0:3], v[128:131], v[224:239]
    buffer_load_dwordx4 v14, s[24:27], s67 offen offset:2048 lds
    ds_read_b64_tr_b16 a[24:25], v34 offset:2176
    ds_read_b64_tr_b16 a[26:27], v34 offset:3712
    s_waitcnt lgkmcnt(10)
    v_mfma_f32_32x32x16_bf16 v[224:239], a[4:7], v[132:135], v[224:239]
    s_barrier
    ds_read_b64_tr_b16 a[28:29], v34 offset:5248
    ds_read_b64_tr_b16 a[30:31], v34 offset:6784
    s_waitcnt lgkmcnt(10)
    v_mfma_f32_32x32x16_bf16 v[224:239], a[8:11], v[136:139], v[224:239]
    buffer_load_dwordx4 v15, s[24:27], s67 offen offset:3072 lds
    ds_read_b64_tr_b16 a[0:1], v34 offset:8320
    ds_read_b64_tr_b16 a[2:3], v34 offset:9856
    s_waitcnt lgkmcnt(10)
    v_mfma_f32_32x32x16_bf16 v[224:239], a[12:15], v[140:143], v[224:239]
    ds_read_b64_tr_b16 a[4:5], v34 offset:11392
    ds_read_b64_tr_b16 a[6:7], v34 offset:12928
    s_waitcnt lgkmcnt(10)
    v_mfma_f32_32x32x16_bf16 v[224:239], a[16:19], v[144:147], v[224:239]
    s_add_u32 m0, s77, 16384
    s_add_u32 s67, s87, 458752
    buffer_load_dwordx4 v12, s[24:27], s67 offen offset:0 lds
    ds_read_b64_tr_b16 a[8:9], v34 offset:14464
    ds_read_b64_tr_b16 a[10:11], v34 offset:16000
    s_waitcnt lgkmcnt(10)
    v_mfma_f32_32x32x16_bf16 v[224:239], a[20:23], v[148:151], v[224:239]
    ds_read_b64_tr_b16 a[12:13], v34 offset:17536
    ds_read_b64_tr_b16 a[14:15], v34 offset:19072
    s_waitcnt lgkmcnt(10)
    v_mfma_f32_32x32x16_bf16 v[224:239], a[24:27], v[152:155], v[224:239]
    buffer_load_dwordx4 v13, s[24:27], s67 offen offset:1024 lds
    ds_read_b64_tr_b16 a[16:17], v34 offset:20608
    ds_read_b64_tr_b16 a[18:19], v34 offset:22144
    s_waitcnt lgkmcnt(10)
    v_mfma_f32_32x32x16_bf16 v[224:239], a[28:31], v[156:159], v[224:239]
    ds_read_b64_tr_b16 a[20:21], v34 offset:23680
    ds_read_b64_tr_b16 a[22:23], v34 offset:25216
    s_waitcnt lgkmcnt(10)
    v_mfma_f32_32x32x16_bf16 v[224:239], a[0:3], v[160:163], v[224:239]
    buffer_load_dwordx4 v14, s[24:27], s67 offen offset:2048 lds
    ds_read_b64_tr_b16 a[24:25], v34 offset:26752
    ds_read_b64_tr_b16 a[26:27], v34 offset:28288
    s_waitcnt lgkmcnt(10)
    v_mfma_f32_32x32x16_bf16 v[224:239], a[4:7], v[164:167], v[224:239]
    ds_read_b64_tr_b16 a[28:29], v34 offset:29824
    ds_read_b64_tr_b16 a[30:31], v34 offset:31360
    s_waitcnt lgkmcnt(10)
    v_mfma_f32_32x32x16_bf16 v[224:239], a[8:11], v[168:171], v[224:239]
    buffer_load_dwordx4 v15, s[24:27], s67 offen offset:3072 lds
    s_waitcnt lgkmcnt(8)
    v_mfma_f32_32x32x16_bf16 v[224:239], a[12:15], v[172:175], v[224:239]
    s_waitcnt lgkmcnt(6)
    v_mfma_f32_32x32x16_bf16 v[224:239], a[16:19], v[176:179], v[224:239]
    s_sub_u32 s64, s6, 16384
    s_waitcnt vmcnt(9)
    s_cmp_lg_u32 s80, 0
    s_mov_b64 exec, 1
    s_cbranch_scc1 L_fl9
    buffer_store_dword v16, v5, s[32:35], s71 offen
L_fl9_r:
    s_mov_b64 exec, -1
    s_add_u32 m0, s77, 32768
    s_add_u32 s67, s87, 851968
    buffer_load_dwordx4 v12, s[24:27], s67 offen offset:0 lds
    s_waitcnt lgkmcnt(4)
    v_mfma_f32_32x32x16_bf16 v[224:239], a[20:23], v[180:183], v[224:239]
    s_waitcnt lgkmcnt(2)
    v_mfma_f32_32x32x16_bf16 v[224:239], a[24:27], v[184:187], v[224:239]
    buffer_load_dword v3, v29, s[32:35], s86 offen sc1
    buffer_load_dwordx4 v13, s[24:27], s67 offen offset:1024 lds
    s_waitcnt lgkmcnt(0)
    v_mfma_f32_32x32x16_bf16 v[224:239], a[28:31], v[188:191], v[224:239]
    s_add_u32 s64, s77, 57344
    v_add_u32 v41, s64, v2
    s_lshl_b32 s64, s59, 2
    v_add_u32 v45, s64, v21
    v_xor_b32 v45, v45, v9
    s_lshl_b32 s64, s58, 12
    v_lshl_add_u32 v45, v45, 4, s64
    v_lshl_add_u32 v45, v20, 7, v45
    buffer_load_dwordx4 v14, s[24:27], s67 offen offset:2048 lds
    s_nop 2
    s_nop 0
    v_pk_fma_f32 v[224:225], v[224:225], v[36:37], v[80:81] op_sel:[0,1,0] op_sel_hi:[1,1,1]
    v_pk_fma_f32 v[226:227], v[226:227], v[36:37], v[82:83] op_sel:[0,1,0] op_sel_hi:[1,1,1]
    v_pk_fma_f32 v[228:229], v[228:229], v[36:37], v[84:85] op_sel:[0,1,0] op_sel_hi:[1,1,1]
    v_pk_fma_f32 v[230:231], v[230:231], v[36:37], v[86:87] op_sel:[0,1,0] op_sel_hi:[1,1,1]
    v_pk_fma_f32 v[232:233], v[232:233], v[36:37], v[88:89] op_sel:[0,1,0] op_sel_hi:[1,1,1]
    v_pk_fma_f32 v[234:235], v[234:235], v[36:37], v[90:91] op_sel:[0,1,0] op_sel_hi:[1,1,1]
    v_pk_fma_f32 v[236:237], v[236:237], v[36:37], v[92:93] op_sel:[0,1,0] op_sel_hi:[1,1,1]
    v_pk_fma_f32 v[238:239], v[238:239], v[36:37], v[94:95] op_sel:[0,1,0] op_sel_hi:[1,1,1]
    buffer_load_dwordx4 v15, s[24:27], s67 offen offset:3072 lds
    v_pk_mul_f32 v[96:97], v[224:225], v[224:225]
    v_pk_mul_f32 v[98:99], v[226:227], v[226:227]
    v_pk_mul_f32 v[100:101], v[228:229], v[228:229]
    v_pk_mul_f32 v[102:103], v[230:231], v[230:231]
    v_pk_mul_f32 v[104:105], v[232:233], v[232:233]
    v_pk_mul_f32 v[106:107], v[234:235], v[234:235]
    v_pk_mul_f32 v[108:109], v[236:237], v[236:237]
    v_pk_mul_f32 v[110:111], v[238:239], v[238:239]
    v_pk_fma_f32 v[96:97], v[96:97], s[78:79], v[42:43] op_sel_hi:[1,0,0]
    v_pk_fma_f32 v[98:99], v[98:99], s[78:79], v[42:43] op_sel_hi:[1,0,0]
    v_pk_fma_f32 v[100:101], v[100:101], s[78:79], v[42:43] op_sel_hi:[1,0,0]
    v_pk_fma_f32 v[102:103], v[102:103], s[78:79], v[42:43] op_sel_hi:[1,0,0]
    v_pk_fma_f32 v[104:105], v[104:105], s[78:79], v[42:43] op_sel_hi:[1,0,0]
    v_pk_fma_f32 v[106:107], v[106:107], s[78:79], v[42:43] op_sel_hi:[1,0,0]
    v_pk_fma_f32 v[108:109], v[108:109], s[78:79], v[42:43] op_sel_hi:[1,0,0]
    v_pk_fma_f32 v[110:111], v[110:111], s[78:79], v[42:43] op_sel_hi:[1,0,0]
    v_pk_mul_f32 v[96:97], v[96:97], v[224:225]
    v_pk_mul_f32 v[98:99], v[98:99], v[226:227]
    v_pk_mul_f32 v[100:101], v[100:101], v[228:229]
    v_pk_mul_f32 v[102:103], v[102:103], v[230:231]
    v_pk_mul_f32 v[104:105], v[104:105], v[232:233]
    v_pk_mul_f32 v[106:107], v[106:107], v[234:235]
    v_pk_mul_f32 v[108:109], v[108:109], v[236:237]
    v_pk_mul_f32 v[110:111], v[110:111], v[238:239]
    v_exp_f32 v96, v96
    v_exp_f32 v97, v97
    v_exp_f32 v98, v98
    v_exp_f32 v99, v99
    s_waitcnt vmcnt(3)
    v_cmp_gt_u32 vcc, 1, v3
    s_cbranch_vccnz L_ap10_s
L_ap10_r:
    buffer_load_dwordx4 a[64:67], v2, s[32:35], s91 offen offset:0 sc1
    buffer_load_dwordx4 a[68:71], v2, s[32:35], s91 offen offset:1024 sc1
    v_exp_f32 v100, v100
    v_exp_f32 v101, v101
    v_exp_f32 v102, v102
    v_exp_f32 v103, v103
    buffer_load_dwordx4 a[72:75], v2, s[32:35], s91 offen offset:2048 sc1
    v_exp_f32 v104, v104
    v_exp_f32 v105, v105
    v_exp_f32 v106, v106
    v_exp_f32 v107, v107
    buffer_load_dwordx4 a[76:79], v2, s[32:35], s91 offen offset:3072 sc1
    v_exp_f32 v108, v108
    v_exp_f32 v109, v109
    v_exp_f32 v110, v110
    v_exp_f32_e64 v111, v111
    s_add_u32 s91, s91, 4096
    buffer_load_dwordx4 a[80:83], v2, s[32:35], s91 offen offset:0 sc1
    v_pk_add_f32 v[96:97], v[96:97], 1.0 op_sel_hi:[1,0]
    v_pk_add_f32 v[98:99], v[98:99], 1.0 op_sel_hi:[1,0]
    v_pk_add_f32 v[100:101], v[100:101], 1.0 op_sel_hi:[1,0]
    v_pk_add_f32 v[102:103], v[102:103], 1.0 op_sel_hi:[1,0]
    v_pk_add_f32 v[104:105], v[104:105], 1.0 op_sel_hi:[1,0]
    v_pk_add_f32 v[106:107], v[106:107], 1.0 op_sel_hi:[1,0]
    v_pk_add_f32 v[108:109], v[108:109], 1.0 op_sel_hi:[1,0]
    v_pk_add_f32 v[110:111], v[110:111], 1.0 op_sel_hi:[1,0]
    buffer_load_dwordx4 a[84:87], v2, s[32:35], s91 offen offset:1024 sc1
    v_rcp_f32 v96, v96
    v_rcp_f32 v97, v97
    v_rcp_f32 v98, v98
    v_rcp_f32 v99, v99
    buffer_load_dwordx4 a[88:91], v2, s[32:35], s91 offen offset:2048 sc1
    v_rcp_f32 v100, v100
    v_rcp_f32 v101, v101
    v_rcp_f32 v102, v102
    v_rcp_f32 v103, v103
    v_pk_mul_f32 v[96:97], v[96:97], v[224:225]
    v_pk_mul_f32 v[98:99], v[98:99], v[226:227]
    v_pk_mul_f32 v[100:101], v[100:101], v[228:229]
    v_pk_mul_f32 v[102:103], v[102:103], v[230:231]
    v_cvt_pk_bf16_f32 v112, v96, v97
    v_cvt_pk_bf16_f32 v113, v98, v99
    v_cvt_pk_bf16_f32 v114, v100, v101
    v_cvt_pk_bf16_f32 v115, v102, v103
    buffer_store_dwordx4 v[112:115], v10, s[32:35], s6 offen sc1
    buffer_load_dwordx4 a[92:95], v2, s[32:35], s91 offen offset:3072 sc1
    v_rcp_f32 v104, v104
    v_rcp_f32 v105, v105
    v_rcp_f32 v106, v106
    v_rcp_f32 v107, v107
    v_rcp_f32 v108, v108
    v_rcp_f32 v109, v109
    v_rcp_f32 v110, v110
    v_rcp_f32 v111, v111
    v_pk_mul_f32 v[104:105], v[104:105], v[232:233]
    v_pk_mul_f32 v[106:107], v[106:107], v[234:235]
    v_pk_mul_f32 v[108:109], v[108:109], v[236:237]
    v_pk_mul_f32 v[110:111], v[110:111], v[238:239]
    v_cvt_pk_bf16_f32 v116, v104, v105
    v_cvt_pk_bf16_f32 v117, v106, v107
    v_cvt_pk_bf16_f32 v118, v108, v109
    v_cvt_pk_bf16_f32 v119, v110, v111
    buffer_store_dwordx4 v[116:119], v56, s[32:35], s6 offen sc1
    s_waitcnt vmcnt(9)
    v_mfma_f32_32x32x16_bf16 v[208:223], a[132:135], a[64:67], 0
    s_add_u32 s91, s91, 4096
    buffer_load_dwordx4 a[96:99], v2, s[32:35], s91 offen offset:0 sc1
    v_mfma_f32_32x32x16_bf16 v[192:207], a[128:131], a[64:67], v[240:255]
    v_xor_b32 v46, 32, v45
    v_xor_b32 v47, v8, v9
    s_lshl_b32 s64, s52, 11
    s_waitcnt vmcnt(9)
    v_mfma_f32_32x32x16_bf16 v[208:223], a[140:143], a[68:71], v[208:223]
    buffer_load_dwordx4 a[100:103], v2, s[32:35], s91 offen offset:1024 sc1
    buffer_load_dword v3, v29, s[32:35], s86 offen sc1
    v_mfma_f32_32x32x16_bf16 v[192:207], a[136:139], a[68:71], v[192:207]
    v_lshl_add_u32 v47, v47, 4, s64
    v_lshl_add_u32 v47, v8, 7, v47
    v_xor_b32 v40, 4096, v41
    s_waitcnt vmcnt(10)
    v_mfma_f32_32x32x16_bf16 v[208:223], a[148:151], a[72:75], v[208:223]
    buffer_load_dwordx4 a[104:107], v2, s[32:35], s91 offen offset:2048 sc1
    v_mfma_f32_32x32x16_bf16 v[192:207], a[144:147], a[72:75], v[192:207]
    s_waitcnt vmcnt(10)
    v_mfma_f32_32x32x16_bf16 v[208:223], a[156:159], a[76:79], v[208:223]
    buffer_load_dwordx4 a[108:111], v2, s[32:35], s91 offen offset:3072 sc1
    v_mfma_f32_32x32x16_bf16 v[192:207], a[152:155], a[76:79], v[192:207]
    s_waitcnt vmcnt(10)
    v_mfma_f32_32x32x16_bf16 v[208:223], a[164:167], a[80:83], v[208:223]
    s_add_u32 s91, s91, 4096
    buffer_load_dwordx4 a[112:115], v2, s[32:35], s91 offen offset:0 sc1
    v_mfma_f32_32x32x16_bf16 v[192:207], a[160:163], a[80:83], v[192:207]
    s_waitcnt vmcnt(10)
    v_mfma_f32_32x32x16_bf16 v[208:223], a[172:175], a[84:87], v[208:223]
    buffer_load_dwordx4 a[116:119], v2, s[32:35], s91 offen offset:1024 sc1
    v_mfma_f32_32x32x16_bf16 v[192:207], a[168:171], a[84:87], v[192:207]
    s_waitcnt vmcnt(10)
    v_mfma_f32_32x32x16_bf16 v[208:223], a[180:183], a[88:91], v[208:223]
    buffer_load_dwordx4 a[120:123], v2, s[32:35], s91 offen offset:2048 sc1
    v_mfma_f32_32x32x16_bf16 v[192:207], a[176:179], a[88:91], v[192:207]
    s_waitcnt vmcnt(9)
    v_mfma_f32_32x32x16_bf16 v[208:223], a[188:191], a[92:95], v[208:223]
    buffer_load_dwordx4 a[124:127], v2, s[32:35], s91 offen offset:3072 sc1
    v_mfma_f32_32x32x16_bf16 v[192:207], a[184:187], a[92:95], v[192:207]
    s_waitcnt vmcnt(8)
    v_mfma_f32_32x32x16_bf16 v[208:223], a[196:199], a[96:99], v[208:223]
    s_waitcnt vmcnt(6)
    v_cmp_gt_u32 vcc, 2, v3
    s_cbranch_vccnz L_ap11_s
L_ap11_r:
    s_add_u32 s91, s91, 4096
    buffer_load_dwordx4 v[128:131], v2, s[32:35], s91 offen offset:0 sc1
    v_mfma_f32_32x32x16_bf16 v[192:207], a[192:195], a[96:99], v[192:207]
    v_mfma_f32_32x32x16_bf16 v[208:223], a[204:207], a[100:103], v[208:223]
    buffer_load_dwordx4 v[132:135], v2, s[32:35], s91 offen offset:1024 sc1
    v_mfma_f32_32x32x16_bf16 v[192:207], a[200:203], a[100:103], v[192:207]
    s_waitcnt vmcnt(7)
    v_mfma_f32_32x32x16_bf16 v[208:223], a[212:215], a[104:107], v[208:223]
    buffer_load_dwordx4 v[136:139], v2, s[32:35], s91 offen offset:2048 sc1
    v_mfma_f32_32x32x16_bf16 v[192:207], a[208:211], a[104:107], v[192:207]
    s_waitcnt vmcnt(7)
    v_mfma_f32_32x32x16_bf16 v[208:223], a[220:223], a[108:111], v[208:223]
    buffer_load_dwordx4 v[140:143], v2, s[32:35], s91 offen offset:3072 sc1
    v_mfma_f32_32x32x16_bf16 v[192:207], a[216:219], a[108:111], v[192:207]
    s_waitcnt vmcnt(7)
    v_mfma_f32_32x32x16_bf16 v[208:223], a[228:231], a[112:115], v[208:223]
    s_cmp_lg_u32 s80, 0
    s_mov_b64 exec, 1
    s_cbranch_scc1 L_fl12
    buffer_store_dword v17, v5, s[32:35], s71 offen
L_fl12_r:
    s_mov_b64 exec, -1
    s_add_u32 s91, s91, 4096
    buffer_load_dwordx4 v[144:147], v2, s[32:35], s91 offen offset:0 sc1
    v_mfma_f32_32x32x16_bf16 v[192:207], a[224:227], a[112:115], v[192:207]
    s_waitcnt vmcnt(8)
    v_mfma_f32_32x32x16_bf16 v[208:223], a[236:239], a[116:119], v[208:223]
    s_barrier
    buffer_load_dwordx4 v[148:151], v2, s[32:35], s91 offen offset:1024 sc1
    v_mfma_f32_32x32x16_bf16 v[192:207], a[232:235], a[116:119], v[192:207]
    ds_read_b64_tr_b16 a[132:133], v33 offset:32768
    ds_read_b64_tr_b16 a[134:135], v33 offset:33792
    ds_read_b64_tr_b16 a[128:129], v32 offset:32768
    ds_read_b64_tr_b16 a[130:131], v32 offset:33792
    s_waitcnt vmcnt(8)
    v_mfma_f32_32x32x16_bf16 v[208:223], a[244:247], a[120:123], v[208:223]
    buffer_load_dwordx4 v[152:155], v2, s[32:35], s91 offen offset:2048 sc1
    v_mfma_f32_32x32x16_bf16 v[192:207], a[240:243], a[120:123], v[192:207]
    ds_read_b64_tr_b16 a[140:141], v33 offset:36864
    ds_read_b64_tr_b16 a[142:143], v33 offset:37888
    ds_read_b64_tr_b16 a[136:137], v32 offset:36864
    ds_read_b64_tr_b16 a[138:139], v32 offset:37888
    s_waitcnt vmcnt(8)
    v_mfma_f32_32x32x16_bf16 v[208:223], a[252:255], a[124:127], v[208:223]
    buffer_load_dwordx4 v[156:159], v2, s[32:35], s91 offen offset:3072 sc1
    v_mfma_f32_32x32x16_bf16 v[192:207], a[248:251], a[124:127], v[192:207]
    ds_read_b64_tr_b16 a[148:149], v33 offset:40960
    ds_read_b64_tr_b16 a[150:151], v33 offset:41984
    ds_read_b64_tr_b16 a[144:145], v32 offset:40960
    ds_read_b64_tr_b16 a[146:147], v32 offset:41984
    s_waitcnt vmcnt(8)
    v_mfma_f32_32x32x16_bf16 v[208:223], a[36:39], v[128:131], v[208:223]
    s_add_u32 s91, s91, 4096
    buffer_load_dwordx4 v[160:163], v2, s[32:35], s91 offen offset:0 sc1
    v_mfma_f32_32x32x16_bf16 v[192:207], a[32:35], v[128:131], v[192:207]
    ds_read_b64_tr_b16 a[156:157], v33 offset:45056
    ds_read_b64_tr_b16 a[158:159], v33 offset:46080
    ds_read_b64_tr_b16 a[152:153], v32 offset:45056
    ds_read_b64_tr_b16 a[154:155], v32 offset:46080
    s_waitcnt vmcnt(8)
    v_mfma_f32_32x32x16_bf16 v[208:223], a[44:47], v[132:135], v[208:223]
    buffer_load_dwordx4 v[164:167], v2, s[32:35], s91 offen offset:1024 sc1
    v_mfma_f32_32x32x16_bf16 v[192:207], a[40:43], v[132:135], v[192:207]
    ds_read_b64_tr_b16 a[164:165], v33 offset:0
    ds_read_b64_tr_b16 a[166:167], v33 offset:1024
    ds_read_b64_tr_b16 a[160:161], v32 offset:0
    ds_read_b64_tr_b16 a[162:163], v32 offset:1024
    s_waitcnt vmcnt(8)
    v_mfma_f32_32x32x16_bf16 v[208:223], a[52:55], v[136:139], v[208:223]
    buffer_load_dwordx4 v[168:171], v2, s[32:35], s91 offen offset:2048 sc1
    v_mfma_f32_32x32x16_bf16 v[192:207], a[48:51], v[136:139], v[192:207]
    ds_read_b64_tr_b16 a[172:173], v33 offset:4096
    ds_read_b64_tr_b16 a[174:175], v33 offset:5120
    ds_read_b64_tr_b16 a[168:169], v32 offset:4096
    ds_read_b64_tr_b16 a[170:171], v32 offset:5120
    s_waitcnt vmcnt(8)
    v_mfma_f32_32x32x16_bf16 v[208:223], a[60:63], v[140:143], v[208:223]
    buffer_load_dwordx4 v[172:175], v2, s[32:35], s91 offen offset:3072 sc1
    buffer_load_dword v3, v29, s[32:35], s86 offen sc1
    v_mfma_f32_32x32x16_bf16 v[192:207], a[56:59], v[140:143], v[192:207]
    ds_read_b64_tr_b16 a[180:181], v33 offset:8192
    ds_read_b64_tr_b16 a[182:183], v33 offset:9216
    ds_read_b64_tr_b16 a[176:177], v32 offset:8192
    ds_read_b64_tr_b16 a[178:179], v32 offset:9216
    s_waitcnt vmcnt(8) lgkmcnt(14)
    v_mfma_f32_32x32x16_bf16 v[208:223], a[132:135], v[144:147], v[208:223]
    s_add_u32 s91, s91, 4096
    buffer_load_dwordx4 v[176:179], v2, s[32:35], s91 offen offset:0 sc1
    v_mfma_f32_32x32x16_bf16 v[192:207], a[128:131], v[144:147], v[192:207]
    ds_read_b64_tr_b16 a[188:189], v33 offset:12288
    ds_read_b64_tr_b16 a[190:191], v33 offset:13312
    ds_read_b64_tr_b16 a[184:185], v32 offset:12288
    ds_read_b64_tr_b16 a[186:187], v32 offset:13312
    s_waitcnt vmcnt(8)
    v_mfma_f32_32x32x16_bf16 v[208:223], a[140:143], v[148:151], v[208:223]
    buffer_load_dwordx4 v[180:183], v2, s[32:35], s91 offen offset:1024 sc1
    v_mfma_f32_32x32x16_bf16 v[192:207], a[136:139], v[148:151], v[192:207]
    ds_read_b64_tr_b16 a[196:197], v33 offset:16384
    ds_read_b64_tr_b16 a[198:199], v33 offset:17408
    ds_read_b64_tr_b16 a[192:193], v32 offset:16384
    ds_read_b64_tr_b16 a[194:195], v32 offset:17408
    s_waitcnt vmcnt(8)
    v_mfma_f32_32x32x16_bf16 v[208:223], a[148:151], v[152:155], v[208:223]
    buffer_load_dwordx4 v[184:187], v2, s[32:35], s91 offen offset:2048 sc1
    v_mfma_f32_32x32x16_bf16 v[192:207], a[144:147], v[152:155], v[192:207]
    ds_read_b64_tr_b16 a[204:205], v33 offset:20480
    ds_read_b64_tr_b16 a[206:207], v33 offset:21504
    ds_read_b64_tr_b16 a[200:201], v32 offset:20480
    ds_read_b64_tr_b16 a[202:203], v32 offset:21504
    s_waitcnt vmcnt(8)
    v_mfma_f32_32x32x16_bf16 v[208:223], a[156:159], v[156:159], v[208:223]
    buffer_load_dwordx4 v[188:191], v2, s[32:35], s91 offen offset:3072 sc1
    s_waitcnt lgkmcnt(14)
    v_mfma_f32_32x32x16_bf16 v[192:207], a[152:155], v[156:159], v[192:207]
    ds_read_b64_tr_b16 a[212:213], v33 offset:24576
    ds_read_b64_tr_b16 a[214:215], v33 offset:25600
    ds_read_b64_tr_b16 a[208:209], v32 offset:24576
    ds_read_b64_tr_b16 a[210:211], v32 offset:25600
    s_waitcnt vmcnt(8)
    v_mfma_f32_32x32x16_bf16 v[208:223], a[164:167], v[160:163], v[208:223]
    v_mfma_f32_32x32x16_bf16 v[192:207], a[160:163], v[160:163], v[192:207]
    ds_read_b64_tr_b16 a[220:221], v33 offset:28672
    ds_read_b64_tr_b16 a[222:223], v33 offset:29696
    ds_read_b64_tr_b16 a[216:217], v32 offset:28672
    ds_read_b64_tr_b16 a[218:219], v32 offset:29696
    s_waitcnt vmcnt(7)
    v_mfma_f32_32x32x16_bf16 v[208:223], a[172:175], v[164:167], v[208:223]
    v_mfma_f32_32x32x16_bf16 v[192:207], a[168:171], v[164:167], v[192:207]
    ds_read_b64_tr_b16 a[228:229], v27 offset:0
    ds_read_b64_tr_b16 a[230:231], v27 offset:1024
    ds_read_b64_tr_b16 a[224:225], v26 offset:0
    ds_read_b64_tr_b16 a[226:227], v26 offset:1024
    s_waitcnt vmcnt(6)
    v_mfma_f32_32x32x16_bf16 v[208:223], a[180:183], v[168:171], v[208:223]
    s_waitcnt vmcnt(4)
    v_cmp_gt_u32 vcc, 3, v3
    s_cbranch_vccnz L_ap13_s
L_ap13_r:
    s_add_u32 s91, s91, 4096
    buffer_load_dwordx4 a[64:67], v2, s[32:35], s91 offen offset:0 sc1
    s_waitcnt lgkmcnt(14)
    v_mfma_f32_32x32x16_bf16 v[192:207], a[176:179], v[168:171], v[192:207]
    buffer_load_dwordx4 a[68:71], v2, s[32:35], s91 offen offset:1024 sc1
    ds_read_b64_tr_b16 a[236:237], v27 offset:4096
    ds_read_b64_tr_b16 a[238:239], v27 offset:5120
    ds_read_b64_tr_b16 a[232:233], v26 offset:4096
    ds_read_b64_tr_b16 a[234:235], v26 offset:5120
    v_mfma_f32_32x32x16_bf16 v[208:223], a[188:191], v[172:175], v[208:223]
    buffer_load_dwordx4 a[72:75], v2, s[32:35], s91 offen offset:2048 sc1
    v_mfma_f32_32x32x16_bf16 v[192:207], a[184:187], v[172:175], v[192:207]
    buffer_load_dwordx4 a[76:79], v2, s[32:35], s91 offen offset:3072 sc1
    ds_read_b64_tr_b16 a[244:245], v27 offset:8192
    ds_read_b64_tr_b16 a[246:247], v27 offset:9216
    ds_read_b64_tr_b16 a[240:241], v26 offset:8192
    ds_read_b64_tr_b16 a[242:243], v26 offset:9216
    s_waitcnt vmcnt(7)
    v_mfma_f32_32x32x16_bf16 v[208:223], a[196:199], v[176:179], v[208:223]
    s_add_u32 s91, s91, 4096
    buffer_load_dwordx4 a[80:83], v2, s[32:35], s91 offen offset:0 sc1
    v_mfma_f32_32x32x16_bf16 v[192:207], a[192:195], v[176:179], v[192:207]
    ds_read_b64_tr_b16 a[252:253], v27 offset:12288
    ds_read_b64_tr_b16 a[254:255], v27 offset:13312
    ds_read_b64_tr_b16 a[248:249], v26 offset:12288
    ds_read_b64_tr_b16 a[250:251], v26 offset:13312
    s_waitcnt vmcnt(7)
    v_mfma_f32_32x32x16_bf16 v[208:223], a[204:207], v[180:183], v[208:223]
    buffer_load_dwordx4 a[84:87], v2, s[32:35], s91 offen offset:1024 sc1
    s_waitcnt lgkmcnt(14)
    v_mfma_f32_32x32x16_bf16 v[192:207], a[200:203], v[180:183], v[192:207]
    ds_read_b64_tr_b16 a[132:133], v27 offset:16384
    ds_read_b64_tr_b16 a[134:135], v27 offset:17408
    ds_read_b64_tr_b16 a[128:129], v26 offset:16384
    ds_read_b64_tr_b16 a[130:131], v26 offset:17408
    s_waitcnt vmcnt(7)
    v_mfma_f32_32x32x16_bf16 v[208:223], a[212:215], v[184:187], v[208:223]
    buffer_load_dwordx4 a[88:91], v2, s[32:35], s91 offen offset:2048 sc1
    v_mfma_f32_32x32x16_bf16 v[192:207], a[208:211], v[184:187], v[192:207]
    ds_read_b64_tr_b16 a[140:141], v27 offset:20480
    ds_read_b64_tr_b16 a[142:143], v27 offset:21504
    ds_read_b64_tr_b16 a[136:137], v26 offset:20480
    ds_read_b64_tr_b16 a[138:139], v26 offset:21504
    s_waitcnt vmcnt(7)
    v_mfma_f32_32x32x16_bf16 v[208:223], a[220:223], v[188:191], v[208:223]
    buffer_load_dwordx4 a[92:95], v2, s[32:35], s91 offen offset:3072 sc1
    v_mfma_f32_32x32x16_bf16 v[192:207], a[216:219], v[188:191], v[192:207]
    ds_read_b64_tr_b16 a[148:149], v27 offset:24576
    ds_read_b64_tr_b16 a[150:151], v27 offset:25600
    ds_read_b64_tr_b16 a[144:145], v26 offset:24576
    ds_read_b64_tr_b16 a[146:147], v26 offset:25600
    s_waitcnt vmcnt(7)
    v_mfma_f32_32x32x16_bf16 v[208:223], a[228:231], a[64:67], v[208:223]
    s_add_u32 s91, s91, 4096
    buffer_load_dwordx4 a[96:99], v2, s[32:35], s91 offen offset:0 sc1
    s_waitcnt lgkmcnt(14)
    v_mfma_f32_32x32x16_bf16 v[192:207], a[224:227], a[64:67], v[192:207]
    ds_read_b64_tr_b16 a[156:157], v27 offset:28672
    ds_read_b64_tr_b16 a[158:159], v27 offset:29696
    ds_read_b64_tr_b16 a[152:153], v26 offset:28672
    ds_read_b64_tr_b16 a[154:155], v26 offset:29696
    s_waitcnt vmcnt(7)
    v_mfma_f32_32x32x16_bf16 v[208:223], a[236:239], a[68:71], v[208:223]
    buffer_load_dwordx4 a[100:103], v2, s[32:35], s91 offen offset:1024 sc1
    v_mfma_f32_32x32x16_bf16 v[192:207], a[232:235], a[68:71], v[192:207]
    ds_read_b64_tr_b16 a[164:165], v27 offset:32768
    ds_read_b64_tr_b16 a[166:167], v27 offset:33792
    ds_read_b64_tr_b16 a[160:161], v26 offset:32768
    ds_read_b64_tr_b16 a[162:163], v26 offset:33792
    s_waitcnt vmcnt(7)
    v_mfma_f32_32x32x16_bf16 v[208:223], a[244:247], a[72:75], v[208:223]
    buffer_load_dwordx4 a[104:107], v2, s[32:35], s91 offen offset:2048 sc1
    ds_read_b64_tr_b16 a[172:173], v27 offset:36864
    ds_read_b64_tr_b16 a[174:175], v27 offset:37888
    ds_read_b64_tr_b16 a[168:169], v26 offset:36864
    ds_read_b64_tr_b16 a[170:171], v26 offset:37888
    v_mfma_f32_32x32x16_bf16 v[192:207], a[240:243], a[72:75], v[192:207]
    ds_read_b64_tr_b16 a[180:181], v27 offset:40960
    ds_read_b64_tr_b16 a[182:183], v27 offset:41984
    ds_read_b64_tr_b16 a[176:177], v26 offset:40960
    ds_read_b64_tr_b16 a[178:179], v26 offset:41984
    s_waitcnt vmcnt(7)
    v_mfma_f32_32x32x16_bf16 v[208:223], a[252:255], a[76:79], v[208:223]
    s_waitcnt lgkmcnt(14)
    v_mfma_f32_32x32x16_bf16 v[192:207], a[248:251], a[76:79], v[192:207]
    s_waitcnt vmcnt(6)
    v_mfma_f32_32x32x16_bf16 v[208:223], a[132:135], a[80:83], v[208:223]
    v_mfma_f32_32x32x16_bf16 v[192:207], a[128:131], a[80:83], v[192:207]
    s_waitcnt vmcnt(5)
    v_mfma_f32_32x32x16_bf16 v[208:223], a[140:143], a[84:87], v[208:223]
    s_waitcnt vmcnt(4)
    v_mfma_f32_32x32x16_bf16 v[208:223], a[148:151], a[88:91], v[208:223]
    s_waitcnt vmcnt(3)
    v_mfma_f32_32x32x16_bf16 v[208:223], a[156:159], a[92:95], v[208:223]
    s_waitcnt vmcnt(2) lgkmcnt(10)
    v_mfma_f32_32x32x16_bf16 v[208:223], a[164:167], a[96:99], v[208:223]
    s_waitcnt vmcnt(1) lgkmcnt(6)
    v_mfma_f32_32x32x16_bf16 v[208:223], a[172:175], a[100:103], v[208:223]
    s_waitcnt vmcnt(0) lgkmcnt(2)
    v_mfma_f32_32x32x16_bf16 v[208:223], a[180:183], a[104:107], v[208:223]
    v_mfma_f32_32x32x16_bf16 v[192:207], a[136:139], a[84:87], v[192:207]
    v_mfma_f32_32x32x16_bf16 v[192:207], a[144:147], a[88:91], v[192:207]
    s_nop 9
    ds_write_b128 v41, v[208:211] offset:0
    v_mfma_f32_32x32x16_bf16 v[192:207], a[152:155], a[92:95], v[192:207]
    ds_write_b128 v41, v[212:215] offset:1024
    v_mfma_f32_32x32x16_bf16 v[192:207], a[160:163], a[96:99], v[192:207]
    ds_write_b128 v41, v[216:219] offset:2048
    v_mfma_f32_32x32x16_bf16 v[192:207], a[168:171], a[100:103], v[192:207]
    ds_write_b128 v41, v[220:223] offset:3072
    s_waitcnt lgkmcnt(4)
    v_mfma_f32_32x32x16_bf16 v[192:207], a[176:179], a[104:107], v[192:207]
    s_waitcnt lgkmcnt(0)
    s_barrier
    ds_read_b128 v[64:67], v40 offset:0
    ds_read_b128 v[68:71], v40 offset:1024
    ds_read_b128 v[72:75], v40 offset:2048
    ds_read_b128 v[76:79], v40 offset:3072
    s_waitcnt lgkmcnt(3)
    s_nop 4
    v_pk_add_f32 v[192:193], v[192:193], v[64:65]
    v_pk_add_f32 v[194:195], v[194:195], v[66:67]
    s_waitcnt lgkmcnt(2)
    v_pk_add_f32 v[196:197], v[196:197], v[68:69]
    v_pk_add_f32 v[198:199], v[198:199], v[70:71]
    v_cvt_pk_bf16_f32 v80, v192, v193
    v_cvt_pk_bf16_f32 v81, v194, v195
    v_cvt_pk_bf16_f32 v82, v196, v197
    v_cvt_pk_bf16_f32 v83, v198, v199
    s_nop 0
    v_permlane32_swap_b32 v80, v82
    v_permlane32_swap_b32 v81, v83
    ds_write_b128 v45, v[80:83] offset:49152
    s_waitcnt lgkmcnt(2)
    v_pk_add_f32 v[200:201], v[200:201], v[72:73]
    v_pk_add_f32 v[202:203], v[202:203], v[74:75]
    s_waitcnt lgkmcnt(1)
    v_pk_add_f32 v[204:205], v[204:205], v[76:77]
    v_pk_add_f32 v[206:207], v[206:207], v[78:79]
    v_cvt_pk_bf16_f32 v84, v200, v201
    v_cvt_pk_bf16_f32 v85, v202, v203
    v_cvt_pk_bf16_f32 v86, v204, v205
    v_cvt_pk_bf16_f32 v87, v206, v207
    s_nop 0
    v_permlane32_swap_b32 v84, v86
    v_permlane32_swap_b32 v85, v87
    ds_write_b128 v46, v[84:87] offset:49152
    s_waitcnt lgkmcnt(0)
    s_barrier
    ds_read_b128 v[88:91], v47 offset:49152
    ds_read_b128 v[92:95], v47 offset:50176
    s_waitcnt lgkmcnt(1)
    buffer_store_dwordx4 v[88:91], v6, s[28:31], 0 offen sc1
    s_waitcnt lgkmcnt(0)
    buffer_store_dwordx4 v[92:95], v11, s[28:31], 0 offen sc1
    s_endpgm
    s_waitcnt vmcnt(0) lgkmcnt(0)
L_head:
    v_mfma_f32_32x32x16_bf16 a[160:175], v[176:179], v[176:179], 0
    s_cmp_ge_u32 s54, 3
    s_cbranch_scc1 L_head_r
    v_mfma_f32_32x32x16_bf16 a[176:191], v[176:179], v[176:179], 0
    s_cmp_ge_u32 s54, 2
    s_cbranch_scc1 L_head_r
    v_mfma_f32_32x32x16_bf16 a[192:207], v[176:179], v[176:179], 0
    s_cmp_ge_u32 s54, 1
    s_cbranch_scc1 L_head_r
    v_mfma_f32_32x32x16_bf16 a[208:223], v[176:179], v[176:179], 0
    s_branch L_head_r
L_ap1_s:
    s_mov_b32 s72, 0
L_ap1:
    buffer_load_dword v3, v196, s[36:39], 0 offen sc1
    s_add_u32 s72, s72, 1
    s_bitcmp1_b32 s72, 20
    s_waitcnt vmcnt(0)
    s_cbranch_scc1 L_ap1_r
    v_cmp_gt_u32 vcc, 1, v3
    s_cbranch_vccnz L_ap1
    s_branch L_ap1_r
L_ap3_s:
    s_mov_b32 s72, 0
L_ap3:
    buffer_load_dword v3, v40, s[32:35], 0 offen sc1
    s_add_u32 s72, s72, 1
    s_bitcmp1_b32 s72, 20
    s_waitcnt vmcnt(0)
    s_cbranch_scc1 L_ap3_r
    v_cmp_gt_u32 vcc, 1, v3
    s_cbranch_vccnz L_ap3
    s_branch L_ap3_r
L_fl4:
    buffer_store_dword v4, v5, s[32:35], s69 offen sc1
    s_branch L_fl4_r
L_fl6:
    buffer_store_dword v4, v5, s[32:35], s70 offen sc1
    s_branch L_fl6_r
L_fl8:
    buffer_store_dword v4, v5, s[32:35], s71 offen sc1
    s_branch L_fl8_r
L_fl9:
    buffer_store_dword v16, v5, s[32:35], s71 offen sc1
    s_branch L_fl9_r
L_ap10_s:
    s_mov_b32 s72, 0
L_ap10:
    buffer_load_dword v3, v29, s[32:35], s86 offen sc1
    s_add_u32 s72, s72, 1
    s_bitcmp1_b32 s72, 20
    s_waitcnt vmcnt(0)
    s_cbranch_scc1 L_ap10_r
    v_cmp_gt_u32 vcc, 1, v3
    s_cbranch_vccnz L_ap10
    s_branch L_ap10_r
L_ap11_s:
    s_mov_b32 s72, 0
L_ap11:
    buffer_load_dword v3, v29, s[32:35], s86 offen sc1
    s_add_u32 s72, s72, 1
    s_bitcmp1_b32 s72, 20
    s_waitcnt vmcnt(0)
    s_cbranch_scc1 L_ap11_r
    v_cmp_gt_u32 vcc, 2, v3
    s_cbranch_vccnz L_ap11
    s_branch L_ap11_r
L_fl12:
    buffer_store_dword v17, v5, s[32:35], s71 offen sc1
    s_branch L_fl12_r
L_ap13_s:
    s_mov_b32 s72, 0
L_ap13:
    buffer_load_dword v3, v29, s[32:35], s86 offen sc1
    s_add_u32 s72, s72, 1
    s_bitcmp1_b32 s72, 20
    s_waitcnt vmcnt(0)
    s_cbranch_scc1 L_ap13_r
    v_cmp_gt_u32 vcc, 3, v3
    s_cbranch_vccnz L_ap13
    s_branch L_ap13_r
L_cold:
L_fallback:
    s_waitcnt vmcnt(0)
    s_nop 15
    v_mov_b32 v78, 0xff7fffff
    v_mfma_f32_32x32x16_bf16 v[80:95], a[240:243], a[248:251], v[208:223]
    s_nop 11
    v_max3_f32 v77, v80, v81, v82
    v_max3_f32 v77, v77, v83, v84
    v_max3_f32 v77, v77, v85, v86
    v_max3_f32 v77, v77, v87, v88
    v_max3_f32 v77, v77, v89, v90
    v_max3_f32 v77, v77, v91, v92
    v_max3_f32 v77, v77, v93, v94
    v_max_f32 v77, v77, v95
    v_max_f32_e64 v78, v78, v77
    v_mfma_f32_32x32x16_bf16 v[80:95], v[204:207], a[248:251], 0
    s_nop 11
    v_max3_f32 v77, v80, v81, v82
    v_max3_f32 v77, v77, v83, v84
    v_max3_f32 v77, v77, v85, v86
    v_max3_f32 v77, v77, v87, v88
    v_max3_f32 v77, v77, v89, v90
    v_max3_f32 v77, v77, v91, v92
    v_max3_f32 v77, v77, v93, v94
    v_max_f32 v77, v77, v95
    s_cmp_eq_u32 s76, 0
    s_cselect_b32 s64, 0xf149f2ca, 0
    v_add_f32 v77, s64, v77
    v_max_f32_e64 v78, v78, v77
    v_mfma_f32_32x32x16_bf16 v[80:95], v[200:203], a[248:251], 0
    s_nop 11
    v_max3_f32 v77, v80, v81, v82
    v_max3_f32 v77, v77, v83, v84
    v_max3_f32 v77, v77, v85, v86
    v_max3_f32 v77, v77, v87, v88
    v_max3_f32 v77, v77, v89, v90
    v_max3_f32 v77, v77, v91, v92
    v_max3_f32 v77, v77, v93, v94
    v_max_f32 v77, v77, v95
    s_cmp_eq_u32 s76, 0
    s_cselect_b32 s64, 0xf149f2ca, 0
    v_add_f32 v77, s64, v77
    v_max_f32_e64 v78, v78, v77
    v_mfma_f32_32x32x16_bf16 v[80:95], v[196:199], a[248:251], 0
    s_nop 11
    v_max3_f32 v77, v80, v81, v82
    v_max3_f32 v77, v77, v83, v84
    v_max3_f32 v77, v77, v85, v86
    v_max3_f32 v77, v77, v87, v88
    v_max3_f32 v77, v77, v89, v90
    v_max3_f32 v77, v77, v91, v92
    v_max3_f32 v77, v77, v93, v94
    v_max_f32 v77, v77, v95
    s_cmp_eq_u32 s75, 0
    s_cselect_b32 s64, 0xf149f2ca, 0
    v_add_f32 v77, s64, v77
    v_max_f32_e64 v78, v78, v77
    v_mfma_f32_32x32x16_bf16 v[80:95], v[192:195], a[248:251], 0
    s_nop 11
    v_max3_f32 v77, v80, v81, v82
    v_max3_f32 v77, v77, v83, v84
    v_max3_f32 v77, v77, v85, v86
    v_max3_f32 v77, v77, v87, v88
    v_max3_f32 v77, v77, v89, v90
    v_max3_f32 v77, v77, v91, v92
    v_max3_f32 v77, v77, v93, v94
    v_max_f32 v77, v77, v95
    s_cmp_eq_u32 s75, 0
    s_cselect_b32 s64, 0xf149f2ca, 0
    v_add_f32 v77, s64, v77
    v_max_f32_e64 v78, v78, v77
    v_mfma_f32_32x32x16_bf16 v[80:95], v[188:191], a[248:251], 0
    s_nop 11
    v_max3_f32 v77, v80, v81, v82
    v_max3_f32 v77, v77, v83, v84
    v_max3_f32 v77, v77, v85, v86
    v_max3_f32 v77, v77, v87, v88
    v_max3_f32 v77, v77, v89, v90
    v_max3_f32 v77, v77, v91, v92
    v_max3_f32 v77, v77, v93, v94
    v_max_f32 v77, v77, v95
    s_cmp_eq_u32 s74, 0
    s_cselect_b32 s64, 0xf149f2ca, 0
    v_add_f32 v77, s64, v77
    v_max_f32_e64 v78, v78, v77
    v_mfma_f32_32x32x16_bf16 v[80:95], v[184:187], a[248:251], 0
    s_nop 11
    v_max3_f32 v77, v80, v81, v82
    v_max3_f32 v77, v77, v83, v84
    v_max3_f32 v77, v77, v85, v86
    v_max3_f32 v77, v77, v87, v88
    v_max3_f32 v77, v77, v89, v90
    v_max3_f32 v77, v77, v91, v92
    v_max3_f32 v77, v77, v93, v94
    v_max_f32 v77, v77, v95
    s_cmp_eq_u32 s74, 0
    s_cselect_b32 s64, 0xf149f2ca, 0
    v_add_f32 v77, s64, v77
    v_max_f32_e64 v78, v78, v77
    v_mfma_f32_32x32x16_bf16 v[80:95], v[180:183], a[248:251], 0
    s_nop 11
    v_max3_f32 v77, v80, v81, v82
    v_max3_f32 v77, v77, v83, v84
    v_max3_f32 v77, v77, v85, v86
    v_max3_f32 v77, v77, v87, v88
    v_max3_f32 v77, v77, v89, v90
    v_max3_f32 v77, v77, v91, v92
    v_max3_f32 v77, v77, v93, v94
    v_max_f32 v77, v77, v95
    s_cmp_eq_u32 s73, 0
    s_cselect_b32 s64, 0xf149f2ca, 0
    v_add_f32 v77, s64, v77
    v_max_f32_e64 v78, v78, v77
    v_mfma_f32_32x32x16_bf16 v[80:95], v[176:179], a[248:251], v[224:239]
    s_nop 11
    v_max3_f32 v77, v80, v81, v82
    v_max3_f32 v77, v77, v83, v84
    v_max3_f32 v77, v77, v85, v86
    v_max3_f32 v77, v77, v87, v88
    v_max3_f32 v77, v77, v89, v90
    v_max3_f32 v77, v77, v91, v92
    v_max3_f32 v77, v77, v93, v94
    v_max_f32 v77, v77, v95
    s_cmp_eq_u32 s73, 0
    s_cselect_b32 s64, 0xf149f2ca, 0
    v_add_f32 v77, s64, v77
    v_max_f32 v78, v78, v77
    v_mov_b32 v77, v78
    s_nop 1
    v_permlane32_swap_b32 v78, v77
    v_max_f32 v78, v78, v77
    v_mfma_f32_32x32x16_bf16 v[80:95], a[240:243], a[248:251], v[208:223]
    s_nop 11
    v_sub_f32 v80, v80, v78
    v_sub_f32 v81, v81, v78
    v_sub_f32 v82, v82, v78
    v_sub_f32 v83, v83, v78
    v_sub_f32 v84, v84, v78
    v_sub_f32 v85, v85, v78
    v_sub_f32 v86, v86, v78
    v_sub_f32 v87, v87, v78
    v_sub_f32 v88, v88, v78
    v_sub_f32 v89, v89, v78
    v_sub_f32 v90, v90, v78
    v_sub_f32 v91, v91, v78
    v_sub_f32 v92, v92, v78
    v_sub_f32 v93, v93, v78
    v_sub_f32 v94, v94, v78
    v_sub_f32 v95, v95, v78
    v_min_f32 v80, 0, v80
    v_min_f32 v81, 0, v81
    v_min_f32 v82, 0, v82
    v_min_f32 v83, 0, v83
    v_min_f32 v84, 0, v84
    v_min_f32 v85, 0, v85
    v_min_f32 v86, 0, v86
    v_min_f32 v87, 0, v87
    v_min_f32 v88, 0, v88
    v_min_f32 v89, 0, v89
    v_min_f32 v90, 0, v90
    v_min_f32 v91, 0, v91
    v_min_f32 v92, 0, v92
    v_min_f32 v93, 0, v93
    v_min_f32 v94, 0, v94
    v_min_f32 v95, 0, v95
    v_exp_f32 v80, v80
    v_exp_f32 v81, v81
    v_exp_f32 v82, v82
    v_exp_f32 v83, v83
    v_exp_f32 v84, v84
    v_exp_f32 v85, v85
    v_exp_f32 v86, v86
    v_exp_f32 v87, v87
    v_exp_f32 v88, v88
    v_exp_f32 v89, v89
    v_exp_f32 v90, v90
    v_exp_f32 v91, v91
    v_exp_f32 v92, v92
    v_exp_f32 v93, v93
    v_exp_f32 v94, v94
    v_exp_f32_e64 v95, v95
    v_cvt_pk_bf16_f32 v112, v80, v81
    v_cvt_pk_bf16_f32 v113, v82, v83
    v_cvt_pk_bf16_f32 v114, v84, v85
    v_cvt_pk_bf16_f32 v115, v86, v87
    v_cvt_pk_bf16_f32 v116, v88, v89
    v_cvt_pk_bf16_f32 v117, v90, v91
    v_cvt_pk_bf16_f32 v118, v92, v93
    v_cvt_pk_bf16_f32 v119, v94, v95
    v_mfma_f32_32x32x16_bf16 v[128:143], a[224:227], v[112:115], 0
    s_nop 0
    v_mfma_f32_32x32x16_bf16 v[128:143], a[228:231], v[116:119], v[128:143]
    v_mfma_f32_32x32x16_bf16 v[80:95], v[204:207], a[248:251], 0
    s_nop 11
    v_sub_f32 v80, v80, v78
    v_sub_f32 v81, v81, v78
    v_sub_f32 v82, v82, v78
    v_sub_f32 v83, v83, v78
    v_sub_f32 v84, v84, v78
    v_sub_f32 v85, v85, v78
    v_sub_f32 v86, v86, v78
    v_sub_f32 v87, v87, v78
    v_sub_f32 v88, v88, v78
    v_sub_f32 v89, v89, v78
    v_sub_f32 v90, v90, v78
    v_sub_f32 v91, v91, v78
    v_sub_f32 v92, v92, v78
    v_sub_f32 v93, v93, v78
    v_sub_f32 v94, v94, v78
    v_sub_f32 v95, v95, v78
    v_min_f32 v80, 0, v80
    v_min_f32 v81, 0, v81
    v_min_f32 v82, 0, v82
    v_min_f32 v83, 0, v83
    v_min_f32 v84, 0, v84
    v_min_f32 v85, 0, v85
    v_min_f32 v86, 0, v86
    v_min_f32 v87, 0, v87
    v_min_f32 v88, 0, v88
    v_min_f32 v89, 0, v89
    v_min_f32 v90, 0, v90
    v_min_f32 v91, 0, v91
    v_min_f32 v92, 0, v92
    v_min_f32 v93, 0, v93
    v_min_f32 v94, 0, v94
    v_min_f32 v95, 0, v95
    v_exp_f32 v80, v80
    v_exp_f32 v81, v81
    v_exp_f32 v82, v82
    v_exp_f32 v83, v83
    v_exp_f32 v84, v84
    v_exp_f32 v85, v85
    v_exp_f32 v86, v86
    v_exp_f32 v87, v87
    v_exp_f32 v88, v88
    v_exp_f32 v89, v89
    v_exp_f32 v90, v90
    v_exp_f32 v91, v91
    v_exp_f32 v92, v92
    v_exp_f32 v93, v93
    v_exp_f32 v94, v94
    v_exp_f32 v95, v95
    v_cvt_pk_bf16_f32 v112, v80, v81
    v_cvt_pk_bf16_f32 v113, v82, v83
    v_cvt_pk_bf16_f32 v114, v84, v85
    v_cvt_pk_bf16_f32 v115, v86, v87
    v_cvt_pk_bf16_f32 v116, v88, v89
    v_cvt_pk_bf16_f32 v117, v90, v91
    v_cvt_pk_bf16_f32 v118, v92, v93
    v_cvt_pk_bf16_f32 v119, v94, v95
    v_mfma_f32_32x32x16_bf16 v[128:143], a[216:219], v[112:115], v[128:143]
    s_nop 0
    v_mfma_f32_32x32x16_bf16 v[128:143], a[220:223], v[116:119], v[128:143]
    v_mfma_f32_32x32x16_bf16 v[80:95], v[200:203], a[248:251], 0
    s_nop 11
    v_sub_f32 v80, v80, v78
    v_sub_f32 v81, v81, v78
    v_sub_f32 v82, v82, v78
    v_sub_f32 v83, v83, v78
    v_sub_f32 v84, v84, v78
    v_sub_f32 v85, v85, v78
    v_sub_f32 v86, v86, v78
    v_sub_f32 v87, v87, v78
    v_sub_f32 v88, v88, v78
    v_sub_f32 v89, v89, v78
    v_sub_f32 v90, v90, v78
    v_sub_f32 v91, v91, v78
    v_sub_f32 v92, v92, v78
    v_sub_f32 v93, v93, v78
    v_sub_f32 v94, v94, v78
    v_sub_f32 v95, v95, v78
    v_min_f32 v80, 0, v80
    v_min_f32 v81, 0, v81
    v_min_f32 v82, 0, v82
    v_min_f32 v83, 0, v83
    v_min_f32 v84, 0, v84
    v_min_f32 v85, 0, v85
    v_min_f32 v86, 0, v86
    v_min_f32 v87, 0, v87
    v_min_f32 v88, 0, v88
    v_min_f32 v89, 0, v89
    v_min_f32 v90, 0, v90
    v_min_f32 v91, 0, v91
    v_min_f32 v92, 0, v92
    v_min_f32 v93, 0, v93
    v_min_f32 v94, 0, v94
    v_min_f32 v95, 0, v95
    v_exp_f32 v80, v80
    v_exp_f32 v81, v81
    v_exp_f32 v82, v82
    v_exp_f32 v83, v83
    v_exp_f32 v84, v84
    v_exp_f32 v85, v85
    v_exp_f32 v86, v86
    v_exp_f32 v87, v87
    v_exp_f32 v88, v88
    v_exp_f32 v89, v89
    v_exp_f32 v90, v90
    v_exp_f32 v91, v91
    v_exp_f32 v92, v92
    v_exp_f32 v93, v93
    v_exp_f32 v94, v94
    v_exp_f32 v95, v95
    v_cvt_pk_bf16_f32 v112, v80, v81
    v_cvt_pk_bf16_f32 v113, v82, v83
    v_cvt_pk_bf16_f32 v114, v84, v85
    v_cvt_pk_bf16_f32 v115, v86, v87
    v_cvt_pk_bf16_f32 v116, v88, v89
    v_cvt_pk_bf16_f32 v117, v90, v91
    v_cvt_pk_bf16_f32 v118, v92, v93
    v_cvt_pk_bf16_f32 v119, v94, v95
    v_mfma_f32_32x32x16_bf16 v[128:143], a[208:211], v[112:115], v[128:143]
    s_nop 0
    v_mfma_f32_32x32x16_bf16 v[128:143], a[212:215], v[116:119], v[128:143]
    v_mfma_f32_32x32x16_bf16 v[80:95], v[196:199], a[248:251], 0
    s_nop 11
    v_sub_f32 v80, v80, v78
    v_sub_f32 v81, v81, v78
    v_sub_f32 v82, v82, v78
    v_sub_f32 v83, v83, v78
    v_sub_f32 v84, v84, v78
    v_sub_f32 v85, v85, v78
    v_sub_f32 v86, v86, v78
    v_sub_f32 v87, v87, v78
    v_sub_f32 v88, v88, v78
    v_sub_f32 v89, v89, v78
    v_sub_f32 v90, v90, v78
    v_sub_f32 v91, v91, v78
    v_sub_f32 v92, v92, v78
    v_sub_f32 v93, v93, v78
    v_sub_f32 v94, v94, v78
    v_sub_f32 v95, v95, v78
    v_min_f32 v80, 0, v80
    v_min_f32 v81, 0, v81
    v_min_f32 v82, 0, v82
    v_min_f32 v83, 0, v83
    v_min_f32 v84, 0, v84
    v_min_f32 v85, 0, v85
    v_min_f32 v86, 0, v86
    v_min_f32 v87, 0, v87
    v_min_f32 v88, 0, v88
    v_min_f32 v89, 0, v89
    v_min_f32 v90, 0, v90
    v_min_f32 v91, 0, v91
    v_min_f32 v92, 0, v92
    v_min_f32 v93, 0, v93
    v_min_f32 v94, 0, v94
    v_min_f32 v95, 0, v95
    v_exp_f32 v80, v80
    v_exp_f32 v81, v81
    v_exp_f32 v82, v82
    v_exp_f32 v83, v83
    v_exp_f32 v84, v84
    v_exp_f32 v85, v85
    v_exp_f32 v86, v86
    v_exp_f32 v87, v87
    v_exp_f32 v88, v88
    v_exp_f32 v89, v89
    v_exp_f32 v90, v90
    v_exp_f32 v91, v91
    v_exp_f32 v92, v92
    v_exp_f32 v93, v93
    v_exp_f32 v94, v94
    v_exp_f32 v95, v95
    v_cvt_pk_bf16_f32 v112, v80, v81
    v_cvt_pk_bf16_f32 v113, v82, v83
    v_cvt_pk_bf16_f32 v114, v84, v85
    v_cvt_pk_bf16_f32 v115, v86, v87
    v_cvt_pk_bf16_f32 v116, v88, v89
    v_cvt_pk_bf16_f32 v117, v90, v91
    v_cvt_pk_bf16_f32 v118, v92, v93
    v_cvt_pk_bf16_f32 v119, v94, v95
    v_mfma_f32_32x32x16_bf16 v[128:143], a[200:203], v[112:115], v[128:143]
    s_nop 0
    v_mfma_f32_32x32x16_bf16 v[128:143], a[204:207], v[116:119], v[128:143]
    v_mfma_f32_32x32x16_bf16 v[80:95], v[192:195], a[248:251], 0
    s_nop 11
    v_sub_f32 v80, v80, v78
    v_sub_f32 v81, v81, v78
    v_sub_f32 v82, v82, v78
    v_sub_f32 v83, v83, v78
    v_sub_f32 v84, v84, v78
    v_sub_f32 v85, v85, v78
    v_sub_f32 v86, v86, v78
    v_sub_f32 v87, v87, v78
    v_sub_f32 v88, v88, v78
    v_sub_f32 v89, v89, v78
    v_sub_f32 v90, v90, v78
    v_sub_f32 v91, v91, v78
    v_sub_f32 v92, v92, v78
    v_sub_f32 v93, v93, v78
    v_sub_f32 v94, v94, v78
    v_sub_f32 v95, v95, v78
    v_min_f32 v80, 0, v80
    v_min_f32 v81, 0, v81
    v_min_f32 v82, 0, v82
    v_min_f32 v83, 0, v83
    v_min_f32 v84, 0, v84
    v_min_f32 v85, 0, v85
    v_min_f32 v86, 0, v86
    v_min_f32 v87, 0, v87
    v_min_f32 v88, 0, v88
    v_min_f32 v89, 0, v89
    v_min_f32 v90, 0, v90
    v_min_f32 v91, 0, v91
    v_min_f32 v92, 0, v92
    v_min_f32 v93, 0, v93
    v_min_f32 v94, 0, v94
    v_min_f32 v95, 0, v95
    v_exp_f32 v80, v80
    v_exp_f32 v81, v81
    v_exp_f32 v82, v82
    v_exp_f32 v83, v83
    v_exp_f32 v84, v84
    v_exp_f32 v85, v85
    v_exp_f32 v86, v86
    v_exp_f32 v87, v87
    v_exp_f32 v88, v88
    v_exp_f32 v89, v89
    v_exp_f32 v90, v90
    v_exp_f32 v91, v91
    v_exp_f32 v92, v92
    v_exp_f32 v93, v93
    v_exp_f32 v94, v94
    v_exp_f32 v95, v95
    v_cvt_pk_bf16_f32 v112, v80, v81
    v_cvt_pk_bf16_f32 v113, v82, v83
    v_cvt_pk_bf16_f32 v114, v84, v85
    v_cvt_pk_bf16_f32 v115, v86, v87
    v_cvt_pk_bf16_f32 v116, v88, v89
    v_cvt_pk_bf16_f32 v117, v90, v91
    v_cvt_pk_bf16_f32 v118, v92, v93
    v_cvt_pk_bf16_f32 v119, v94, v95
    v_mfma_f32_32x32x16_bf16 v[128:143], a[192:195], v[112:115], v[128:143]
    s_nop 0
    v_mfma_f32_32x32x16_bf16 v[128:143], a[196:199], v[116:119], v[128:143]
    v_mfma_f32_32x32x16_bf16 v[80:95], v[188:191], a[248:251], 0
    s_nop 11
    v_sub_f32 v80, v80, v78
    v_sub_f32 v81, v81, v78
    v_sub_f32 v82, v82, v78
    v_sub_f32 v83, v83, v78
    v_sub_f32 v84, v84, v78
    v_sub_f32 v85, v85, v78
    v_sub_f32 v86, v86, v78
    v_sub_f32 v87, v87, v78
    v_sub_f32 v88, v88, v78
    v_sub_f32 v89, v89, v78
    v_sub_f32 v90, v90, v78
    v_sub_f32 v91, v91, v78
    v_sub_f32 v92, v92, v78
    v_sub_f32 v93, v93, v78
    v_sub_f32 v94, v94, v78
    v_sub_f32 v95, v95, v78
    v_min_f32 v80, 0, v80
    v_min_f32 v81, 0, v81
    v_min_f32 v82, 0, v82
    v_min_f32 v83, 0, v83
    v_min_f32 v84, 0, v84
    v_min_f32 v85, 0, v85
    v_min_f32 v86, 0, v86
    v_min_f32 v87, 0, v87
    v_min_f32 v88, 0, v88
    v_min_f32 v89, 0, v89
    v_min_f32 v90, 0, v90
    v_min_f32 v91, 0, v91
    v_min_f32 v92, 0, v92
    v_min_f32 v93, 0, v93
    v_min_f32 v94, 0, v94
    v_min_f32 v95, 0, v95
    v_exp_f32 v80, v80
    v_exp_f32 v81, v81
    v_exp_f32 v82, v82
    v_exp_f32 v83, v83
    v_exp_f32 v84, v84
    v_exp_f32 v85, v85
    v_exp_f32 v86, v86
    v_exp_f32 v87, v87
    v_exp_f32 v88, v88
    v_exp_f32 v89, v89
    v_exp_f32 v90, v90
    v_exp_f32 v91, v91
    v_exp_f32 v92, v92
    v_exp_f32 v93, v93
    v_exp_f32 v94, v94
    v_exp_f32 v95, v95
    v_cvt_pk_bf16_f32 v112, v80, v81
    v_cvt_pk_bf16_f32 v113, v82, v83
    v_cvt_pk_bf16_f32 v114, v84, v85
    v_cvt_pk_bf16_f32 v115, v86, v87
    v_cvt_pk_bf16_f32 v116, v88, v89
    v_cvt_pk_bf16_f32 v117, v90, v91
    v_cvt_pk_bf16_f32 v118, v92, v93
    v_cvt_pk_bf16_f32 v119, v94, v95
    v_mfma_f32_32x32x16_bf16 v[128:143], a[184:187], v[112:115], v[128:143]
    s_nop 0
    v_mfma_f32_32x32x16_bf16 v[128:143], a[188:191], v[116:119], v[128:143]
    v_mfma_f32_32x32x16_bf16 v[80:95], v[184:187], a[248:251], 0
    s_nop 11
    v_sub_f32 v80, v80, v78
    v_sub_f32 v81, v81, v78
    v_sub_f32 v82, v82, v78
    v_sub_f32 v83, v83, v78
    v_sub_f32 v84, v84, v78
    v_sub_f32 v85, v85, v78
    v_sub_f32 v86, v86, v78
    v_sub_f32 v87, v87, v78
    v_sub_f32 v88, v88, v78
    v_sub_f32 v89, v89, v78
    v_sub_f32 v90, v90, v78
    v_sub_f32 v91, v91, v78
    v_sub_f32 v92, v92, v78
    v_sub_f32 v93, v93, v78
    v_sub_f32 v94, v94, v78
    v_sub_f32 v95, v95, v78
    v_min_f32 v80, 0, v80
    v_min_f32 v81, 0, v81
    v_min_f32 v82, 0, v82
    v_min_f32 v83, 0, v83
    v_min_f32 v84, 0, v84
    v_min_f32 v85, 0, v85
    v_min_f32 v86, 0, v86
    v_min_f32 v87, 0, v87
    v_min_f32 v88, 0, v88
    v_min_f32 v89, 0, v89
    v_min_f32 v90, 0, v90
    v_min_f32 v91, 0, v91
    v_min_f32 v92, 0, v92
    v_min_f32 v93, 0, v93
    v_min_f32 v94, 0, v94
    v_min_f32 v95, 0, v95
    v_exp_f32 v80, v80
    v_exp_f32 v81, v81
    v_exp_f32 v82, v82
    v_exp_f32 v83, v83
    v_exp_f32 v84, v84
    v_exp_f32 v85, v85
    v_exp_f32 v86, v86
    v_exp_f32 v87, v87
    v_exp_f32 v88, v88
    v_exp_f32 v89, v89
    v_exp_f32 v90, v90
    v_exp_f32 v91, v91
    v_exp_f32 v92, v92
    v_exp_f32 v93, v93
    v_exp_f32 v94, v94
    v_exp_f32 v95, v95
    v_cvt_pk_bf16_f32 v112, v80, v81
    v_cvt_pk_bf16_f32 v113, v82, v83
    v_cvt_pk_bf16_f32 v114, v84, v85
    v_cvt_pk_bf16_f32 v115, v86, v87
    v_cvt_pk_bf16_f32 v116, v88, v89
    v_cvt_pk_bf16_f32 v117, v90, v91
    v_cvt_pk_bf16_f32 v118, v92, v93
    v_cvt_pk_bf16_f32 v119, v94, v95
    v_mfma_f32_32x32x16_bf16 v[128:143], a[176:179], v[112:115], v[128:143]
    s_nop 0
    v_mfma_f32_32x32x16_bf16 v[128:143], a[180:183], v[116:119], v[128:143]
    v_mfma_f32_32x32x16_bf16 v[80:95], v[180:183], a[248:251], 0
    s_nop 11
    v_sub_f32 v80, v80, v78
    v_sub_f32 v81, v81, v78
    v_sub_f32 v82, v82, v78
    v_sub_f32 v83, v83, v78
    v_sub_f32 v84, v84, v78
    v_sub_f32 v85, v85, v78
    v_sub_f32 v86, v86, v78
    v_sub_f32 v87, v87, v78
    v_sub_f32 v88, v88, v78
    v_sub_f32 v89, v89, v78
    v_sub_f32 v90, v90, v78
    v_sub_f32 v91, v91, v78
    v_sub_f32 v92, v92, v78
    v_sub_f32 v93, v93, v78
    v_sub_f32 v94, v94, v78
    v_sub_f32 v95, v95, v78
    v_min_f32 v80, 0, v80
    v_min_f32 v81, 0, v81
    v_min_f32 v82, 0, v82
    v_min_f32 v83, 0, v83
    v_min_f32 v84, 0, v84
    v_min_f32 v85, 0, v85
    v_min_f32 v86, 0, v86
    v_min_f32 v87, 0, v87
    v_min_f32 v88, 0, v88
    v_min_f32 v89, 0, v89
    v_min_f32 v90, 0, v90
    v_min_f32 v91, 0, v91
    v_min_f32 v92, 0, v92
    v_min_f32 v93, 0, v93
    v_min_f32 v94, 0, v94
    v_min_f32 v95, 0, v95
    v_exp_f32 v80, v80
    v_exp_f32 v81, v81
    v_exp_f32 v82, v82
    v_exp_f32 v83, v83
    v_exp_f32 v84, v84
    v_exp_f32 v85, v85
    v_exp_f32 v86, v86
    v_exp_f32 v87, v87
    v_exp_f32 v88, v88
    v_exp_f32 v89, v89
    v_exp_f32 v90, v90
    v_exp_f32 v91, v91
    v_exp_f32 v92, v92
    v_exp_f32 v93, v93
    v_exp_f32 v94, v94
    v_exp_f32 v95, v95
    v_cvt_pk_bf16_f32 v112, v80, v81
    v_cvt_pk_bf16_f32 v113, v82, v83
    v_cvt_pk_bf16_f32 v114, v84, v85
    v_cvt_pk_bf16_f32 v115, v86, v87
    v_cvt_pk_bf16_f32 v116, v88, v89
    v_cvt_pk_bf16_f32 v117, v90, v91
    v_cvt_pk_bf16_f32 v118, v92, v93
    v_cvt_pk_bf16_f32 v119, v94, v95
    v_mfma_f32_32x32x16_bf16 v[128:143], a[168:171], v[112:115], v[128:143]
    s_nop 0
    v_mfma_f32_32x32x16_bf16 v[128:143], a[172:175], v[116:119], v[128:143]
    v_mfma_f32_32x32x16_bf16 v[80:95], v[176:179], a[248:251], v[224:239]
    s_nop 11
    v_sub_f32 v80, v80, v78
    v_sub_f32 v81, v81, v78
    v_sub_f32 v82, v82, v78
    v_sub_f32 v83, v83, v78
    v_sub_f32 v84, v84, v78
    v_sub_f32 v85, v85, v78
    v_sub_f32 v86, v86, v78
    v_sub_f32 v87, v87, v78
    v_sub_f32 v88, v88, v78
    v_sub_f32 v89, v89, v78
    v_sub_f32 v90, v90, v78
    v_sub_f32 v91, v91, v78
    v_sub_f32 v92, v92, v78
    v_sub_f32 v93, v93, v78
    v_sub_f32 v94, v94, v78
    v_sub_f32 v95, v95, v78
    v_min_f32 v80, 0, v80
    v_min_f32 v81, 0, v81
    v_min_f32 v82, 0, v82
    v_min_f32 v83, 0, v83
    v_min_f32 v84, 0, v84
    v_min_f32 v85, 0, v85
    v_min_f32 v86, 0, v86
    v_min_f32 v87, 0, v87
    v_min_f32 v88, 0, v88
    v_min_f32 v89, 0, v89
    v_min_f32 v90, 0, v90
    v_min_f32 v91, 0, v91
    v_min_f32 v92, 0, v92
    v_min_f32 v93, 0, v93
    v_min_f32 v94, 0, v94
    v_min_f32 v95, 0, v95
    v_exp_f32 v80, v80
    v_exp_f32 v81, v81
    v_exp_f32 v82, v82
    v_exp_f32 v83, v83
    v_exp_f32 v84, v84
    v_exp_f32 v85, v85
    v_exp_f32 v86, v86
    v_exp_f32 v87, v87
    v_exp_f32 v88, v88
    v_exp_f32 v89, v89
    v_exp_f32 v90, v90
    v_exp_f32 v91, v91
    v_exp_f32 v92, v92
    v_exp_f32 v93, v93
    v_exp_f32 v94, v94
    v_exp_f32 v95, v95
    v_cvt_pk_bf16_f32 v112, v80, v81
    v_cvt_pk_bf16_f32 v113, v82, v83
    v_cvt_pk_bf16_f32 v114, v84, v85
    v_cvt_pk_bf16_f32 v115, v86, v87
    v_cvt_pk_bf16_f32 v116, v88, v89
    v_cvt_pk_bf16_f32 v117, v90, v91
    v_cvt_pk_bf16_f32 v118, v92, v93
    v_cvt_pk_bf16_f32 v119, v94, v95
    v_mfma_f32_32x32x16_bf16 v[128:143], a[160:163], v[112:115], v[128:143]
    s_nop 0
    v_mfma_f32_32x32x16_bf16 v[128:143], a[164:167], v[116:119], v[128:143]
    v_mov_b32 v78, 0xff7fffff
    v_mfma_f32_32x32x16_bf16 v[80:95], a[240:243], a[252:255], 0
    s_nop 11
    v_max3_f32 v77, v80, v81, v82
    v_max3_f32 v77, v77, v83, v84
    v_max3_f32 v77, v77, v85, v86
    v_max3_f32 v77, v77, v87, v88
    v_max3_f32 v77, v77, v89, v90
    v_max3_f32 v77, v77, v91, v92
    v_max3_f32 v77, v77, v93, v94
    v_max_f32 v77, v77, v95
    v_max_f32_e64 v78, v78, v77
    v_mfma_f32_32x32x16_bf16 v[80:95], a[244:247], a[252:255], v[208:223]
    s_nop 11
    v_max3_f32 v77, v80, v81, v82
    v_max3_f32 v77, v77, v83, v84
    v_max3_f32 v77, v77, v85, v86
    v_max3_f32 v77, v77, v87, v88
    v_max3_f32 v77, v77, v89, v90
    v_max3_f32 v77, v77, v91, v92
    v_max3_f32 v77, v77, v93, v94
    v_max_f32 v77, v77, v95
    v_max_f32_e64 v78, v78, v77
    v_mfma_f32_32x32x16_bf16 v[80:95], v[204:207], a[252:255], 0
    s_nop 11
    v_max3_f32 v77, v80, v81, v82
    v_max3_f32 v77, v77, v83, v84
    v_max3_f32 v77, v77, v85, v86
    v_max3_f32 v77, v77, v87, v88
    v_max3_f32 v77, v77, v89, v90
    v_max3_f32 v77, v77, v91, v92
    v_max3_f32 v77, v77, v93, v94
    v_max_f32 v77, v77, v95
    s_cmp_eq_u32 s76, 0
    s_cselect_b32 s64, 0xf149f2ca, 0
    v_add_f32 v77, s64, v77
    v_max_f32_e64 v78, v78, v77
    v_mfma_f32_32x32x16_bf16 v[80:95], v[200:203], a[252:255], 0
    s_nop 11
    v_max3_f32 v77, v80, v81, v82
    v_max3_f32 v77, v77, v83, v84
    v_max3_f32 v77, v77, v85, v86
    v_max3_f32 v77, v77, v87, v88
    v_max3_f32 v77, v77, v89, v90
    v_max3_f32 v77, v77, v91, v92
    v_max3_f32 v77, v77, v93, v94
    v_max_f32 v77, v77, v95
    s_cmp_eq_u32 s76, 0
    s_cselect_b32 s64, 0xf149f2ca, 0
    v_add_f32 v77, s64, v77
    v_max_f32_e64 v78, v78, v77
    v_mfma_f32_32x32x16_bf16 v[80:95], v[196:199], a[252:255], 0
    s_nop 11
    v_max3_f32 v77, v80, v81, v82
    v_max3_f32 v77, v77, v83, v84
    v_max3_f32 v77, v77, v85, v86
    v_max3_f32 v77, v77, v87, v88
    v_max3_f32 v77, v77, v89, v90
    v_max3_f32 v77, v77, v91, v92
    v_max3_f32 v77, v77, v93, v94
    v_max_f32 v77, v77, v95
    s_cmp_eq_u32 s75, 0
    s_cselect_b32 s64, 0xf149f2ca, 0
    v_add_f32 v77, s64, v77
    v_max_f32_e64 v78, v78, v77
    v_mfma_f32_32x32x16_bf16 v[80:95], v[192:195], a[252:255], 0
    s_nop 11
    v_max3_f32 v77, v80, v81, v82
    v_max3_f32 v77, v77, v83, v84
    v_max3_f32 v77, v77, v85, v86
    v_max3_f32 v77, v77, v87, v88
    v_max3_f32 v77, v77, v89, v90
    v_max3_f32 v77, v77, v91, v92
    v_max3_f32 v77, v77, v93, v94
    v_max_f32 v77, v77, v95
    s_cmp_eq_u32 s75, 0
    s_cselect_b32 s64, 0xf149f2ca, 0
    v_add_f32 v77, s64, v77
    v_max_f32_e64 v78, v78, v77
    v_mfma_f32_32x32x16_bf16 v[80:95], v[188:191], a[252:255], 0
    s_nop 11
    v_max3_f32 v77, v80, v81, v82
    v_max3_f32 v77, v77, v83, v84
    v_max3_f32 v77, v77, v85, v86
    v_max3_f32 v77, v77, v87, v88
    v_max3_f32 v77, v77, v89, v90
    v_max3_f32 v77, v77, v91, v92
    v_max3_f32 v77, v77, v93, v94
    v_max_f32 v77, v77, v95
    s_cmp_eq_u32 s74, 0
    s_cselect_b32 s64, 0xf149f2ca, 0
    v_add_f32 v77, s64, v77
    v_max_f32_e64 v78, v78, v77
    v_mfma_f32_32x32x16_bf16 v[80:95], v[184:187], a[252:255], 0
    s_nop 11
    v_max3_f32 v77, v80, v81, v82
    v_max3_f32 v77, v77, v83, v84
    v_max3_f32 v77, v77, v85, v86
    v_max3_f32 v77, v77, v87, v88
    v_max3_f32 v77, v77, v89, v90
    v_max3_f32 v77, v77, v91, v92
    v_max3_f32 v77, v77, v93, v94
    v_max_f32 v77, v77, v95
    s_cmp_eq_u32 s74, 0
    s_cselect_b32 s64, 0xf149f2ca, 0
    v_add_f32 v77, s64, v77
    v_max_f32_e64 v78, v78, v77
    v_mfma_f32_32x32x16_bf16 v[80:95], v[180:183], a[252:255], v[224:239]
    s_nop 11
    v_max3_f32 v77, v80, v81, v82
    v_max3_f32 v77, v77, v83, v84
    v_max3_f32 v77, v77, v85, v86
    v_max3_f32 v77, v77, v87, v88
    v_max3_f32 v77, v77, v89, v90
    v_max3_f32 v77, v77, v91, v92
    v_max3_f32 v77, v77, v93, v94
    v_max_f32 v77, v77, v95
    s_cmp_eq_u32 s73, 0
    s_cselect_b32 s64, 0xf149f2ca, 0
    v_add_f32 v77, s64, v77
    v_max_f32 v78, v78, v77
    v_mov_b32 v77, v78
    s_nop 1
    v_permlane32_swap_b32 v78, v77
    v_max_f32 v78, v78, v77
    v_mfma_f32_32x32x16_bf16 v[80:95], a[240:243], a[252:255], 0
    s_nop 11
    v_sub_f32 v80, v80, v78
    v_sub_f32 v81, v81, v78
    v_sub_f32 v82, v82, v78
    v_sub_f32 v83, v83, v78
    v_sub_f32 v84, v84, v78
    v_sub_f32 v85, v85, v78
    v_sub_f32 v86, v86, v78
    v_sub_f32 v87, v87, v78
    v_sub_f32 v88, v88, v78
    v_sub_f32 v89, v89, v78
    v_sub_f32 v90, v90, v78
    v_sub_f32 v91, v91, v78
    v_sub_f32 v92, v92, v78
    v_sub_f32 v93, v93, v78
    v_sub_f32 v94, v94, v78
    v_sub_f32 v95, v95, v78
    v_min_f32 v80, 0, v80
    v_min_f32 v81, 0, v81
    v_min_f32 v82, 0, v82
    v_min_f32 v83, 0, v83
    v_min_f32 v84, 0, v84
    v_min_f32 v85, 0, v85
    v_min_f32 v86, 0, v86
    v_min_f32 v87, 0, v87
    v_min_f32 v88, 0, v88
    v_min_f32 v89, 0, v89
    v_min_f32 v90, 0, v90
    v_min_f32 v91, 0, v91
    v_min_f32 v92, 0, v92
    v_min_f32 v93, 0, v93
    v_min_f32 v94, 0, v94
    v_min_f32 v95, 0, v95
    v_exp_f32 v80, v80
    v_exp_f32 v81, v81
    v_exp_f32 v82, v82
    v_exp_f32 v83, v83
    v_exp_f32 v84, v84
    v_exp_f32 v85, v85
    v_exp_f32 v86, v86
    v_exp_f32 v87, v87
    v_exp_f32 v88, v88
    v_exp_f32 v89, v89
    v_exp_f32 v90, v90
    v_exp_f32 v91, v91
    v_exp_f32 v92, v92
    v_exp_f32 v93, v93
    v_exp_f32 v94, v94
    v_exp_f32_e64 v95, v95
    v_cvt_pk_bf16_f32 v112, v80, v81
    v_cvt_pk_bf16_f32 v113, v82, v83
    v_cvt_pk_bf16_f32 v114, v84, v85
    v_cvt_pk_bf16_f32 v115, v86, v87
    v_cvt_pk_bf16_f32 v116, v88, v89
    v_cvt_pk_bf16_f32 v117, v90, v91
    v_cvt_pk_bf16_f32 v118, v92, v93
    v_cvt_pk_bf16_f32 v119, v94, v95
    v_mfma_f32_32x32x16_bf16 v[144:159], a[224:227], v[112:115], 0
    s_nop 0
    v_mfma_f32_32x32x16_bf16 v[144:159], a[228:231], v[116:119], v[144:159]
    v_mfma_f32_32x32x16_bf16 v[80:95], a[244:247], a[252:255], v[208:223]
    s_nop 11
    v_sub_f32 v80, v80, v78
    v_sub_f32 v81, v81, v78
    v_sub_f32 v82, v82, v78
    v_sub_f32 v83, v83, v78
    v_sub_f32 v84, v84, v78
    v_sub_f32 v85, v85, v78
    v_sub_f32 v86, v86, v78
    v_sub_f32 v87, v87, v78
    v_sub_f32 v88, v88, v78
    v_sub_f32 v89, v89, v78
    v_sub_f32 v90, v90, v78
    v_sub_f32 v91, v91, v78
    v_sub_f32 v92, v92, v78
    v_sub_f32 v93, v93, v78
    v_sub_f32 v94, v94, v78
    v_sub_f32 v95, v95, v78
    v_min_f32 v80, 0, v80
    v_min_f32 v81, 0, v81
    v_min_f32 v82, 0, v82
    v_min_f32 v83, 0, v83
    v_min_f32 v84, 0, v84
    v_min_f32 v85, 0, v85
    v_min_f32 v86, 0, v86
    v_min_f32 v87, 0, v87
    v_min_f32 v88, 0, v88
    v_min_f32 v89, 0, v89
    v_min_f32 v90, 0, v90
    v_min_f32 v91, 0, v91
    v_min_f32 v92, 0, v92
    v_min_f32 v93, 0, v93
    v_min_f32 v94, 0, v94
    v_min_f32 v95, 0, v95
    v_exp_f32 v80, v80
    v_exp_f32 v81, v81
    v_exp_f32 v82, v82
    v_exp_f32 v83, v83
    v_exp_f32 v84, v84
    v_exp_f32 v85, v85
    v_exp_f32 v86, v86
    v_exp_f32 v87, v87
    v_exp_f32 v88, v88
    v_exp_f32 v89, v89
    v_exp_f32 v90, v90
    v_exp_f32 v91, v91
    v_exp_f32 v92, v92
    v_exp_f32 v93, v93
    v_exp_f32 v94, v94
    v_exp_f32 v95, v95
    v_cvt_pk_bf16_f32 v112, v80, v81
    v_cvt_pk_bf16_f32 v113, v82, v83
    v_cvt_pk_bf16_f32 v114, v84, v85
    v_cvt_pk_bf16_f32 v115, v86, v87
    v_cvt_pk_bf16_f32 v116, v88, v89
    v_cvt_pk_bf16_f32 v117, v90, v91
    v_cvt_pk_bf16_f32 v118, v92, v93
    v_cvt_pk_bf16_f32 v119, v94, v95
    v_mfma_f32_32x32x16_bf16 v[144:159], a[232:235], v[112:115], v[144:159]
    s_nop 0
    v_mfma_f32_32x32x16_bf16 v[144:159], a[236:239], v[116:119], v[144:159]
    v_mfma_f32_32x32x16_bf16 v[80:95], v[204:207], a[252:255], 0
    s_nop 11
    v_sub_f32 v80, v80, v78
    v_sub_f32 v81, v81, v78
    v_sub_f32 v82, v82, v78
    v_sub_f32 v83, v83, v78
    v_sub_f32 v84, v84, v78
    v_sub_f32 v85, v85, v78
    v_sub_f32 v86, v86, v78
    v_sub_f32 v87, v87, v78
    v_sub_f32 v88, v88, v78
    v_sub_f32 v89, v89, v78
    v_sub_f32 v90, v90, v78
    v_sub_f32 v91, v91, v78
    v_sub_f32 v92, v92, v78
    v_sub_f32 v93, v93, v78
    v_sub_f32 v94, v94, v78
    v_sub_f32 v95, v95, v78
    v_min_f32 v80, 0, v80
    v_min_f32 v81, 0, v81
    v_min_f32 v82, 0, v82
    v_min_f32 v83, 0, v83
    v_min_f32 v84, 0, v84
    v_min_f32 v85, 0, v85
    v_min_f32 v86, 0, v86
    v_min_f32 v87, 0, v87
    v_min_f32 v88, 0, v88
    v_min_f32 v89, 0, v89
    v_min_f32 v90, 0, v90
    v_min_f32 v91, 0, v91
    v_min_f32 v92, 0, v92
    v_min_f32 v93, 0, v93
    v_min_f32 v94, 0, v94
    v_min_f32 v95, 0, v95
    v_exp_f32 v80, v80
    v_exp_f32 v81, v81
    v_exp_f32 v82, v82
    v_exp_f32 v83, v83
    v_exp_f32 v84, v84
    v_exp_f32 v85, v85
    v_exp_f32 v86, v86
    v_exp_f32 v87, v87
    v_exp_f32 v88, v88
    v_exp_f32 v89, v89
    v_exp_f32 v90, v90
    v_exp_f32 v91, v91
    v_exp_f32 v92, v92
    v_exp_f32 v93, v93
    v_exp_f32 v94, v94
    v_exp_f32 v95, v95
    v_cvt_pk_bf16_f32 v112, v80, v81
    v_cvt_pk_bf16_f32 v113, v82, v83
    v_cvt_pk_bf16_f32 v114, v84, v85
    v_cvt_pk_bf16_f32 v115, v86, v87
    v_cvt_pk_bf16_f32 v116, v88, v89
    v_cvt_pk_bf16_f32 v117, v90, v91
    v_cvt_pk_bf16_f32 v118, v92, v93
    v_cvt_pk_bf16_f32 v119, v94, v95
    v_mfma_f32_32x32x16_bf16 v[144:159], a[216:219], v[112:115], v[144:159]
    s_nop 0
    v_mfma_f32_32x32x16_bf16 v[144:159], a[220:223], v[116:119], v[144:159]
    v_mfma_f32_32x32x16_bf16 v[80:95], v[200:203], a[252:255], 0
    s_nop 11
    v_sub_f32 v80, v80, v78
    v_sub_f32 v81, v81, v78
    v_sub_f32 v82, v82, v78
    v_sub_f32 v83, v83, v78
    v_sub_f32 v84, v84, v78
    v_sub_f32 v85, v85, v78
    v_sub_f32 v86, v86, v78
    v_sub_f32 v87, v87, v78
    v_sub_f32 v88, v88, v78
    v_sub_f32 v89, v89, v78
    v_sub_f32 v90, v90, v78
    v_sub_f32 v91, v91, v78
    v_sub_f32 v92, v92, v78
    v_sub_f32 v93, v93, v78
    v_sub_f32 v94, v94, v78
    v_sub_f32 v95, v95, v78
    v_min_f32 v80, 0, v80
    v_min_f32 v81, 0, v81
    v_min_f32 v82, 0, v82
    v_min_f32 v83, 0, v83
    v_min_f32 v84, 0, v84
    v_min_f32 v85, 0, v85
    v_min_f32 v86, 0, v86
    v_min_f32 v87, 0, v87
    v_min_f32 v88, 0, v88
    v_min_f32 v89, 0, v89
    v_min_f32 v90, 0, v90
    v_min_f32 v91, 0, v91
    v_min_f32 v92, 0, v92
    v_min_f32 v93, 0, v93
    v_min_f32 v94, 0, v94
    v_min_f32 v95, 0, v95
    v_exp_f32 v80, v80
    v_exp_f32 v81, v81
    v_exp_f32 v82, v82
    v_exp_f32 v83, v83
    v_exp_f32 v84, v84
    v_exp_f32 v85, v85
    v_exp_f32 v86, v86
    v_exp_f32 v87, v87
    v_exp_f32 v88, v88
    v_exp_f32 v89, v89
    v_exp_f32 v90, v90
    v_exp_f32 v91, v91
    v_exp_f32 v92, v92
    v_exp_f32 v93, v93
    v_exp_f32 v94, v94
    v_exp_f32 v95, v95
    v_cvt_pk_bf16_f32 v112, v80, v81
    v_cvt_pk_bf16_f32 v113, v82, v83
    v_cvt_pk_bf16_f32 v114, v84, v85
    v_cvt_pk_bf16_f32 v115, v86, v87
    v_cvt_pk_bf16_f32 v116, v88, v89
    v_cvt_pk_bf16_f32 v117, v90, v91
    v_cvt_pk_bf16_f32 v118, v92, v93
    v_cvt_pk_bf16_f32 v119, v94, v95
    v_mfma_f32_32x32x16_bf16 v[144:159], a[208:211], v[112:115], v[144:159]
    s_nop 0
    v_mfma_f32_32x32x16_bf16 v[144:159], a[212:215], v[116:119], v[144:159]
    v_mfma_f32_32x32x16_bf16 v[80:95], v[196:199], a[252:255], 0
    s_nop 11
    v_sub_f32 v80, v80, v78
    v_sub_f32 v81, v81, v78
    v_sub_f32 v82, v82, v78
    v_sub_f32 v83, v83, v78
    v_sub_f32 v84, v84, v78
    v_sub_f32 v85, v85, v78
    v_sub_f32 v86, v86, v78
    v_sub_f32 v87, v87, v78
    v_sub_f32 v88, v88, v78
    v_sub_f32 v89, v89, v78
    v_sub_f32 v90, v90, v78
    v_sub_f32 v91, v91, v78
    v_sub_f32 v92, v92, v78
    v_sub_f32 v93, v93, v78
    v_sub_f32 v94, v94, v78
    v_sub_f32 v95, v95, v78
    v_min_f32 v80, 0, v80
    v_min_f32 v81, 0, v81
    v_min_f32 v82, 0, v82
    v_min_f32 v83, 0, v83
    v_min_f32 v84, 0, v84
    v_min_f32 v85, 0, v85
    v_min_f32 v86, 0, v86
    v_min_f32 v87, 0, v87
    v_min_f32 v88, 0, v88
    v_min_f32 v89, 0, v89
    v_min_f32 v90, 0, v90
    v_min_f32 v91, 0, v91
    v_min_f32 v92, 0, v92
    v_min_f32 v93, 0, v93
    v_min_f32 v94, 0, v94
    v_min_f32 v95, 0, v95
    v_exp_f32 v80, v80
    v_exp_f32 v81, v81
    v_exp_f32 v82, v82
    v_exp_f32 v83, v83
    v_exp_f32 v84, v84
    v_exp_f32 v85, v85
    v_exp_f32 v86, v86
    v_exp_f32 v87, v87
    v_exp_f32 v88, v88
    v_exp_f32 v89, v89
    v_exp_f32 v90, v90
    v_exp_f32 v91, v91
    v_exp_f32 v92, v92
    v_exp_f32 v93, v93
    v_exp_f32 v94, v94
    v_exp_f32 v95, v95
    v_cvt_pk_bf16_f32 v112, v80, v81
    v_cvt_pk_bf16_f32 v113, v82, v83
    v_cvt_pk_bf16_f32 v114, v84, v85
    v_cvt_pk_bf16_f32 v115, v86, v87
    v_cvt_pk_bf16_f32 v116, v88, v89
    v_cvt_pk_bf16_f32 v117, v90, v91
    v_cvt_pk_bf16_f32 v118, v92, v93
    v_cvt_pk_bf16_f32 v119, v94, v95
    v_mfma_f32_32x32x16_bf16 v[144:159], a[200:203], v[112:115], v[144:159]
    s_nop 0
    v_mfma_f32_32x32x16_bf16 v[144:159], a[204:207], v[116:119], v[144:159]
    v_mfma_f32_32x32x16_bf16 v[80:95], v[192:195], a[252:255], 0
    s_nop 11
    v_sub_f32 v80, v80, v78
    v_sub_f32 v81, v81, v78
    v_sub_f32 v82, v82, v78
    v_sub_f32 v83, v83, v78
    v_sub_f32 v84, v84, v78
    v_sub_f32 v85, v85, v78
    v_sub_f32 v86, v86, v78
    v_sub_f32 v87, v87, v78
    v_sub_f32 v88, v88, v78
    v_sub_f32 v89, v89, v78
    v_sub_f32 v90, v90, v78
    v_sub_f32 v91, v91, v78
    v_sub_f32 v92, v92, v78
    v_sub_f32 v93, v93, v78
    v_sub_f32 v94, v94, v78
    v_sub_f32 v95, v95, v78
    v_min_f32 v80, 0, v80
    v_min_f32 v81, 0, v81
    v_min_f32 v82, 0, v82
    v_min_f32 v83, 0, v83
    v_min_f32 v84, 0, v84
    v_min_f32 v85, 0, v85
    v_min_f32 v86, 0, v86
    v_min_f32 v87, 0, v87
    v_min_f32 v88, 0, v88
    v_min_f32 v89, 0, v89
    v_min_f32 v90, 0, v90
    v_min_f32 v91, 0, v91
    v_min_f32 v92, 0, v92
    v_min_f32 v93, 0, v93
    v_min_f32 v94, 0, v94
    v_min_f32 v95, 0, v95
    v_exp_f32 v80, v80
    v_exp_f32 v81, v81
    v_exp_f32 v82, v82
    v_exp_f32 v83, v83
    v_exp_f32 v84, v84
    v_exp_f32 v85, v85
    v_exp_f32 v86, v86
    v_exp_f32 v87, v87
    v_exp_f32 v88, v88
    v_exp_f32 v89, v89
    v_exp_f32 v90, v90
    v_exp_f32 v91, v91
    v_exp_f32 v92, v92
    v_exp_f32 v93, v93
    v_exp_f32 v94, v94
    v_exp_f32 v95, v95
    v_cvt_pk_bf16_f32 v112, v80, v81
    v_cvt_pk_bf16_f32 v113, v82, v83
    v_cvt_pk_bf16_f32 v114, v84, v85
    v_cvt_pk_bf16_f32 v115, v86, v87
    v_cvt_pk_bf16_f32 v116, v88, v89
    v_cvt_pk_bf16_f32 v117, v90, v91
    v_cvt_pk_bf16_f32 v118, v92, v93
    v_cvt_pk_bf16_f32 v119, v94, v95
    v_mfma_f32_32x32x16_bf16 v[144:159], a[192:195], v[112:115], v[144:159]
    s_nop 0
    v_mfma_f32_32x32x16_bf16 v[144:159], a[196:199], v[116:119], v[144:159]
    v_mfma_f32_32x32x16_bf16 v[80:95], v[188:191], a[252:255], 0
    s_nop 11
    v_sub_f32 v80, v80, v78
    v_sub_f32 v81, v81, v78
    v_sub_f32 v82, v82, v78
    v_sub_f32 v83, v83, v78
    v_sub_f32 v84, v84, v78
    v_sub_f32 v85, v85, v78
    v_sub_f32 v86, v86, v78
    v_sub_f32 v87, v87, v78
    v_sub_f32 v88, v88, v78
    v_sub_f32 v89, v89, v78
    v_sub_f32 v90, v90, v78
    v_sub_f32 v91, v91, v78
    v_sub_f32 v92, v92, v78
    v_sub_f32 v93, v93, v78
    v_sub_f32 v94, v94, v78
    v_sub_f32 v95, v95, v78
    v_min_f32 v80, 0, v80
    v_min_f32 v81, 0, v81
    v_min_f32 v82, 0, v82
    v_min_f32 v83, 0, v83
    v_min_f32 v84, 0, v84
    v_min_f32 v85, 0, v85
    v_min_f32 v86, 0, v86
    v_min_f32 v87, 0, v87
    v_min_f32 v88, 0, v88
    v_min_f32 v89, 0, v89
    v_min_f32 v90, 0, v90
    v_min_f32 v91, 0, v91
    v_min_f32 v92, 0, v92
    v_min_f32 v93, 0, v93
    v_min_f32 v94, 0, v94
    v_min_f32 v95, 0, v95
    v_exp_f32 v80, v80
    v_exp_f32 v81, v81
    v_exp_f32 v82, v82
    v_exp_f32 v83, v83
    v_exp_f32 v84, v84
    v_exp_f32 v85, v85
    v_exp_f32 v86, v86
    v_exp_f32 v87, v87
    v_exp_f32 v88, v88
    v_exp_f32 v89, v89
    v_exp_f32 v90, v90
    v_exp_f32 v91, v91
    v_exp_f32 v92, v92
    v_exp_f32 v93, v93
    v_exp_f32 v94, v94
    v_exp_f32 v95, v95
    v_cvt_pk_bf16_f32 v112, v80, v81
    v_cvt_pk_bf16_f32 v113, v82, v83
    v_cvt_pk_bf16_f32 v114, v84, v85
    v_cvt_pk_bf16_f32 v115, v86, v87
    v_cvt_pk_bf16_f32 v116, v88, v89
    v_cvt_pk_bf16_f32 v117, v90, v91
    v_cvt_pk_bf16_f32 v118, v92, v93
    v_cvt_pk_bf16_f32 v119, v94, v95
    v_mfma_f32_32x32x16_bf16 v[144:159], a[184:187], v[112:115], v[144:159]
    s_nop 0
    v_mfma_f32_32x32x16_bf16 v[144:159], a[188:191], v[116:119], v[144:159]
    v_mfma_f32_32x32x16_bf16 v[80:95], v[184:187], a[252:255], 0
    s_nop 11
    v_sub_f32 v80, v80, v78
    v_sub_f32 v81, v81, v78
    v_sub_f32 v82, v82, v78
    v_sub_f32 v83, v83, v78
    v_sub_f32 v84, v84, v78
    v_sub_f32 v85, v85, v78
    v_sub_f32 v86, v86, v78
    v_sub_f32 v87, v87, v78
    v_sub_f32 v88, v88, v78
    v_sub_f32 v89, v89, v78
    v_sub_f32 v90, v90, v78
    v_sub_f32 v91, v91, v78
    v_sub_f32 v92, v92, v78
    v_sub_f32 v93, v93, v78
    v_sub_f32 v94, v94, v78
    v_sub_f32 v95, v95, v78
    v_min_f32 v80, 0, v80
    v_min_f32 v81, 0, v81
    v_min_f32 v82, 0, v82
    v_min_f32 v83, 0, v83
    v_min_f32 v84, 0, v84
    v_min_f32 v85, 0, v85
    v_min_f32 v86, 0, v86
    v_min_f32 v87, 0, v87
    v_min_f32 v88, 0, v88
    v_min_f32 v89, 0, v89
    v_min_f32 v90, 0, v90
    v_min_f32 v91, 0, v91
    v_min_f32 v92, 0, v92
    v_min_f32 v93, 0, v93
    v_min_f32 v94, 0, v94
    v_min_f32 v95, 0, v95
    v_exp_f32 v80, v80
    v_exp_f32 v81, v81
    v_exp_f32 v82, v82
    v_exp_f32 v83, v83
    v_exp_f32 v84, v84
    v_exp_f32 v85, v85
    v_exp_f32 v86, v86
    v_exp_f32 v87, v87
    v_exp_f32 v88, v88
    v_exp_f32 v89, v89
    v_exp_f32 v90, v90
    v_exp_f32 v91, v91
    v_exp_f32 v92, v92
    v_exp_f32 v93, v93
    v_exp_f32 v94, v94
    v_exp_f32 v95, v95
    v_cvt_pk_bf16_f32 v112, v80, v81
    v_cvt_pk_bf16_f32 v113, v82, v83
    v_cvt_pk_bf16_f32 v114, v84, v85
    v_cvt_pk_bf16_f32 v115, v86, v87
    v_cvt_pk_bf16_f32 v116, v88, v89
    v_cvt_pk_bf16_f32 v117, v90, v91
    v_cvt_pk_bf16_f32 v118, v92, v93
    v_cvt_pk_bf16_f32 v119, v94, v95
    v_mfma_f32_32x32x16_bf16 v[144:159], a[176:179], v[112:115], v[144:159]
    s_nop 0
    v_mfma_f32_32x32x16_bf16 v[144:159], a[180:183], v[116:119], v[144:159]
    v_mfma_f32_32x32x16_bf16 v[80:95], v[180:183], a[252:255], v[224:239]
    s_nop 11
    v_sub_f32 v80, v80, v78
    v_sub_f32 v81, v81, v78
    v_sub_f32 v82, v82, v78
    v_sub_f32 v83, v83, v78
    v_sub_f32 v84, v84, v78
    v_sub_f32 v85, v85, v78
    v_sub_f32 v86, v86, v78
    v_sub_f32 v87, v87, v78
    v_sub_f32 v88, v88, v78
    v_sub_f32 v89, v89, v78
    v_sub_f32 v90, v90, v78
    v_sub_f32 v91, v91, v78
    v_sub_f32 v92, v92, v78
    v_sub_f32 v93, v93, v78
    v_sub_f32 v94, v94, v78
    v_sub_f32 v95, v95, v78
    v_min_f32 v80, 0, v80
    v_min_f32 v81, 0, v81
    v_min_f32 v82, 0, v82
    v_min_f32 v83, 0, v83
    v_min_f32 v84, 0, v84
    v_min_f32 v85, 0, v85
    v_min_f32 v86, 0, v86
    v_min_f32 v87, 0, v87
    v_min_f32 v88, 0, v88
    v_min_f32 v89, 0, v89
    v_min_f32 v90, 0, v90
    v_min_f32 v91, 0, v91
    v_min_f32 v92, 0, v92
    v_min_f32 v93, 0, v93
    v_min_f32 v94, 0, v94
    v_min_f32 v95, 0, v95
    v_exp_f32 v80, v80
    v_exp_f32 v81, v81
    v_exp_f32 v82, v82
    v_exp_f32 v83, v83
    v_exp_f32 v84, v84
    v_exp_f32 v85, v85
    v_exp_f32 v86, v86
    v_exp_f32 v87, v87
    v_exp_f32 v88, v88
    v_exp_f32 v89, v89
    v_exp_f32 v90, v90
    v_exp_f32 v91, v91
    v_exp_f32 v92, v92
    v_exp_f32 v93, v93
    v_exp_f32 v94, v94
    v_exp_f32 v95, v95
    v_cvt_pk_bf16_f32 v112, v80, v81
    v_cvt_pk_bf16_f32 v113, v82, v83
    v_cvt_pk_bf16_f32 v114, v84, v85
    v_cvt_pk_bf16_f32 v115, v86, v87
    v_cvt_pk_bf16_f32 v116, v88, v89
    v_cvt_pk_bf16_f32 v117, v90, v91
    v_cvt_pk_bf16_f32 v118, v92, v93
    v_cvt_pk_bf16_f32 v119, v94, v95
    v_mfma_f32_32x32x16_bf16 v[144:159], a[168:171], v[112:115], v[144:159]
    s_nop 0
    v_mfma_f32_32x32x16_bf16 v[144:159], a[172:175], v[116:119], v[144:159]
    s_waitcnt vmcnt(0)
    v_rcp_f32 v136, v136
    s_nop 0
    v_pk_mul_f32 v[128:129], v[128:129], v[136:137] op_sel_hi:[1,0]
    v_pk_mul_f32 v[130:131], v[130:131], v[136:137] op_sel_hi:[1,0]
    v_pk_mul_f32 v[132:133], v[132:133], v[136:137] op_sel_hi:[1,0]
    v_pk_mul_f32 v[134:135], v[134:135], v[136:137] op_sel_hi:[1,0]
    v_cvt_pk_bf16_f32 v72, v128, v129
    v_cvt_pk_bf16_f32 v73, v130, v131
    v_cvt_pk_bf16_f32 v74, v132, v133
    v_cvt_pk_bf16_f32 v75, v134, v135
    buffer_store_dwordx4 v[72:75], v2, s[32:35], s92 offen sc1
    v_rcp_f32 v152, v152
    s_nop 0
    v_pk_mul_f32 v[144:145], v[144:145], v[152:153] op_sel_hi:[1,0]
    v_pk_mul_f32 v[146:147], v[146:147], v[152:153] op_sel_hi:[1,0]
    v_pk_mul_f32 v[148:149], v[148:149], v[152:153] op_sel_hi:[1,0]
    v_pk_mul_f32 v[150:151], v[150:151], v[152:153] op_sel_hi:[1,0]
    v_cvt_pk_bf16_f32 v64, v144, v145
    v_cvt_pk_bf16_f32 v65, v146, v147
    v_cvt_pk_bf16_f32 v66, v148, v149
    v_cvt_pk_bf16_f32 v67, v150, v151
    buffer_store_dwordx4 v[64:67], v2, s[32:35], s93 offen sc1
    s_waitcnt vmcnt(0)
    s_branch L_fbret
L_end:
    s_endpgm
.section .rodata,"a"
.p2align 6
.amdhsa_kernel sequential_preLN__sliding_block__mixer_channel_mlp__prompt_kernel
  .amdhsa_next_free_vgpr 512
  .amdhsa_next_free_sgpr 102
  .amdhsa_accum_offset 256
  .amdhsa_group_segment_fixed_size 0
  .amdhsa_kernarg_size 88
  .amdhsa_user_sgpr_count 2
  .amdhsa_user_sgpr_kernarg_segment_ptr 1
  .amdhsa_system_sgpr_workgroup_id_x 1
.end_amdhsa_kernel
```
